```python
import torch

def _softmax(x, axis=-1):
    return torch.softmax(x, dim=axis)
def _gelu(x):
    return torch.nn.functional.gelu(x, approximate="tanh")
def _silu(x):
    return torch.nn.functional.silu(x)
def _sigmoid(x):
    return torch.sigmoid(x)
def _layernorm(x, axis=-1, eps=1e-5):
    m = x.mean(dim=axis, keepdim=True)
    v = x.var(dim=axis, keepdim=True, unbiased=False)
    return (x - m) / torch.sqrt(v + eps)
def _scatter_add(tgt, idx, src, axis=0):
    return tgt.clone().index_add_(axis, idx, src)
def _segment_sum(src, seg, n):
    out = torch.zeros((n,) + src.shape[1:], dtype=src.dtype)
    return out.index_add_(0, seg, src)
def _pad(x, pw):
    flat = tuple(v for pair in reversed(pw) for v in pair)
    return torch.nn.functional.pad(x, flat)

kernel_name = 'gated_mix__linear_kernel_hedgehog__softmax_full_mha__prompt'

def setup_inputs():

    _w = (lambda a: (lambda t: t.to(torch.bfloat16) if t.is_floating_point() else t)(torch.as_tensor(a)))
    def _A_setup():
        B, S, D, H = 1, 2048, 448, 16
        Dh = D // H
        return {
            "x": _w((lambda *s: torch.randn(*s, dtype=torch.bfloat16) * 0.05)(B, S, D)),
            "wqkv": _w((lambda *s: torch.randn(*s, dtype=torch.bfloat16) * 3.2)(D, 3 * D)),
            "w_phi": _w((lambda *s: torch.randn(*s, dtype=torch.bfloat16) * 3.2)(H, Dh, Dh) * (Dh ** -0.5)),
            "wo": _w((lambda *s: torch.randn(*s, dtype=torch.bfloat16) * 0.05)(D, D)),
        }
    _A_in = _A_setup()

    def _B_setup():
        B, S, D = 1, 2048, 448
        return {
            "x": _w((lambda *s: torch.randn(*s, dtype=torch.bfloat16) * 0.05)(B, S, D)),
            "wqkv": _w((lambda *s: torch.randn(*s, dtype=torch.bfloat16) * 1.6)(D, 3 * D)),
            "wo": _w((lambda *s: torch.randn(*s, dtype=torch.bfloat16) * 0.05)(D, D)),
        }
    _B_in = _B_setup()

    return {
        "A_x": _A_in["x"],
        "A_wqkv": _A_in["wqkv"],
        "A_w_phi": _A_in["w_phi"],
        "A_wo": _A_in["wo"],
        "B_x": _B_in["x"],
        "B_wqkv": _B_in["wqkv"],
        "B_wo": _B_in["wo"],
        "gate_w": _w((lambda *s: torch.randn(*s, dtype=torch.bfloat16) * 0.05)(448) * 16.0),
    }

def reference(A_x, A_wqkv, A_w_phi, A_wo, B_x, B_wqkv, B_wo, gate_w):
    def _A_ref(x, wqkv, w_phi, wo):
        B, S, D = x.shape
        H = 16; Dh = D // H
        qkv = (lambda x, *d: x.permute(*d))((x @ wqkv).reshape(B, S, 3, H, Dh), 2, 0, 3, 1, 4)
        q, k, v = qkv[0], qkv[1], qkv[2]
        pq = torch.einsum("bhsd,hdf->bhsf", q, w_phi)
        pk = torch.einsum("bhsd,hdf->bhsf", k, w_phi)
        phi_q = torch.concatenate([_softmax(pq, axis=-1), _softmax(-pq, axis=-1)], axis=-1)
        phi_k = torch.concatenate([_softmax(pk, axis=-1), _softmax(-pk, axis=-1)], axis=-1)
        kv = torch.einsum("bhsf,bhsd->bhfd", phi_k, v)
        z  = torch.einsum("bhsf->bhf", phi_k)
        num = torch.einsum("bhqf,bhfd->bhqd", phi_q, kv)
        den = torch.einsum("bhqf,bhf->bhq", phi_q, z)[..., None] + 1e-6
        o = num / den
        return (lambda x, *d: x.permute(*d))(o, 0, 2, 1, 3).reshape(B, S, D) @ wo

    def _B_ref(x, wqkv, wo):
        B, S, D = x.shape
        H = 16; Dh = D // H
        qkv = (lambda x, *d: x.permute(*d))((x @ wqkv).reshape(B, S, 3, H, Dh), 2, 0, 3, 1, 4)
        q, k, v = qkv[0], qkv[1], qkv[2]
        scale = Dh ** -0.5
        scores = torch.einsum("bhqd,bhkd->bhqk", q, k) * scale
        p = _softmax(scores, axis=-1)
        o = torch.einsum("bhqk,bhkd->bhqd", p, v)
        return (lambda x, *d: x.permute(*d))(o, 0, 2, 1, 3).reshape(B, S, D) @ wo

    x = A_x
    g = _sigmoid((x * gate_w).sum(-1, keepdims=True))
    a = _A_ref(x, A_wqkv, A_w_phi, A_wo)
    b = _B_ref(x, B_wqkv, B_wo)
    return g * a + (1 - g) * b
```

```asm
; @launch grid=(256,1,1) block=(256,1,1) lds=163840
.amdgcn_target "amdgcn-amd-amdhsa--gfx950"
.text
.globl gated_mix__linear_kernel_hedgehog__softmax_full_mha__prompt_kernel
.p2align 8
.type gated_mix__linear_kernel_hedgehog__softmax_full_mha__prompt_kernel,@function
gated_mix__linear_kernel_hedgehog__softmax_full_mha__prompt_kernel:
    s_cmp_ge_u32 s2, 256
    s_cbranch_scc1 L_end
    s_load_dwordx16 s[4:19], s[0:1], 0
    s_load_dwordx4 s[20:23], s[0:1], 64
    s_load_dwordx2 s[24:25], s[0:1], 80
    v_and_b32 v1, 63, v0
    v_lshrrev_b32 v3, 6, v0
    v_lshlrev_b32 v7, 4, v1
    v_readfirstlane_b32 s50, v3
    s_getpc_b64 s[40:41]
L_pc0:
    s_mov_b32 s42, L_code_end-L_pc0
    s_mov_b32 s43, 0x00020000
    s_lshr_b32 s57, s2, 3
    s_lshl_b32 s57, s57, 2
    s_add_u32 s57, s57, s50
    s_lshl_b32 s57, s57, 8
    v_lshlrev_b32 v6, 7, v1
    s_mov_b64 exec, 3
    buffer_load_dword v250, v6, s[40:43], s57 offen
    s_mov_b64 exec, -1
    s_bfe_u32 s44, s2, 0x20003
    s_lshr_b32 s3, s2, 5
    s_lshl_b32 s3, s3, 3
    s_and_b32 s57, s2, 7
    s_add_u32 s3, s3, s57
    s_mul_i32 s26, s3, 37
    s_lshr_b32 s26, s26, 8
    s_mul_i32 s57, s26, 7
    s_sub_u32 s57, s3, s57
    s_lshl_b32 s57, s57, 2
    s_add_u32 s27, s57, s50
    s_mul_i32 s52, s27, 43008
    s_lshl_b32 s57, s26, 1
    s_lshr_b32 s57, 549, s57
    s_and_b32 s57, s57, 3
    s_lshl_b32 s57, s57, 2
    s_add_u32 s57, s57, s44
    s_mul_i32 s57, s57, 224
    s_add_u32 s52, s52, s57
    s_movk_i32 s58, 4682
    s_movk_i32 s59, 2464
    v_mul_u32_u24 v3, s58, v1
    v_lshrrev_b32 v4, 16, v3
    v_mad_u32_u24 v100, v4, s59, v7
    v_add_u32 v3, 299648, v3
    v_lshrrev_b32 v4, 16, v3
    v_mad_u32_u24 v101, v4, s59, v7
    v_add_u32 v3, 299648, v3
    v_lshrrev_b32 v4, 16, v3
    v_mad_u32_u24 v102, v4, s59, v7
    v_add_u32 v3, 299648, v3
    v_lshrrev_b32 v4, 16, v3
    v_mad_u32_u24 v103, v4, s59, v7
    s_mul_i32 s57, s50, 3584
    s_add_u32 m0, s57, 114688
    s_mov_b32 s35, 0x00020000
    s_mov_b32 s34, 0x126000
    s_bitcmp1_b32 38, s26
    s_waitcnt lgkmcnt(0)
    s_cselect_b32 s32, s14, s6
    s_cselect_b32 s33, s15, s7
    s_cmp_ge_u32 s3, 42
    s_cbranch_scc1 L_np
    buffer_load_dwordx4 v100, s[32:35], s52 offen offset:0 nt lds
    buffer_load_dwordx4 v101, s[32:35], s52 offen offset:1024 nt lds
    buffer_load_dwordx4 v102, s[32:35], s52 offen offset:2048 nt lds
    s_mov_b32 exec_hi, 0
    buffer_load_dwordx4 v103, s[32:35], s52 offen offset:3072 nt lds
    s_mov_b64 exec, -1
    s_mov_b32 s40, s18
    s_mov_b32 s41, s19
    s_cmp_eq_u32 s26, 5
    s_cselect_b32 s42, 896, 0
    s_lshl_b32 s57, s27, 5
    v_lshrrev_b32 v5, 1, v1
    v_and_b32 v5, 16, v5
    s_mov_b32 s13, 7897088
    s_load_dword s12, s[24:25], s13
    buffer_load_dwordx4 v[176:179], v5, s[40:43], s57 offen
L_np1:
    s_mov_b32 s40, s8
    s_mov_b32 s41, s9
    s_cmp_lt_u32 s50, 2
    s_cselect_b32 s42, 25088, 0
    v_lshrrev_b32 v2, 5, v1
    s_and_b32 s57, s2, 7
    s_lshr_b32 s61, s2, 3
    s_and_b32 s49, s57, 1
    s_lshl_b32 s49, s49, 3
    s_and_b32 s58, s61, 7
    s_add_u32 s49, s49, s58
    s_lshr_b32 s48, s57, 1
    s_lshl_b32 s48, s48, 2
    s_lshr_b32 s58, s61, 3
    s_add_u32 s48, s48, s58
    s_lshl_b32 s57, s49, 2
    s_add_u32 s54, s57, s50
    s_mul_i32 s51, s54, 28672
    s_mul_i32 s68, s50, 28672
    s_mov_b32 s28, s4
    s_mov_b32 s29, s5
    s_mov_b32 s30, 0x1c0000
    s_mov_b32 s31, 0x00020000
    s_mov_b32 s36, s24
    s_mov_b32 s37, s25
    s_mov_b32 s38, 0xbbb000
    s_mov_b32 s39, 0x00020000
    v_lshrrev_b32 v3, 3, v1
    v_mul_u32_u24 v3, 896, v3
    v_lshrrev_b32 v4, 4, v1
    v_and_b32 v5, 7, v1
    v_xor_b32 v4, v4, v5
    v_lshl_add_u32 v96, v4, 4, v3
    v_xor_b32 v4, 4, v4
    v_lshl_add_u32 v97, v4, 4, v3
    v_add_u32 v97, 6144, v97
    v_add_u32 v98, 12288, v96
    v_add_u32 v99, 12288, v97
    s_mov_b32 s62, 0
    s_mov_b32 s63, -1
    v_and_b32 v3, 31, v1
    v_cmp_gt_u32 vcc, 28, v3
    v_bfe_u32 v4, v1, 2, 2
    v_lshl_add_u32 v6, v2, 3, v4
    v_cndmask_b32 v61, 0, -1, vcc
    v_cmp_eq_u32 vcc, 28, v3
    v_mul_u32_u24 v108, 224, v6
    v_lshl_add_u32 v6, v2, 2, v4
    v_cndmask_b32 v93, 0, -1, vcc
    v_mul_u32_u24 v92, 56, v6
    v_bfe_u32 v4, v1, 4, 1
    v_and_b32 v6, 3, v1
    v_lshl_add_u32 v4, v4, 2, v6
    v_lshl_add_u32 v108, v4, 3, v108
    v_cmp_eq_u32 vcc, 7, v4
    s_mul_i32 s57, s50, 3584
    s_add_u32 s57, s57, 114688
    v_add_u32 v108, s57, v108
    v_cndmask_b32 v4, v4, 0, vcc
    v_lshl_add_u32 v92, v4, 3, v92
    v_add_u32 v92, 129024, v92
    s_lshl_b32 s57, s48, 6
    v_mov_b32 v5, 0x3f803f80
    s_add_u32 s57, s57, s54
    v_and_b32 v62, v5, v93
    s_mul_i32 s46, s57, 4352
    v_cndmask_b32 v63, 0, v5, s[62:63]
    s_add_u32 s46, s46, 2752512
    v_lshrrev_b32 v64, 16, v63
    s_lshl_b32 s9, s57, 7
    v_cndmask_b32 v10, -1, 0, s[62:63]
    s_add_u32 s9, s9, 7208960
    v_and_b32 v65, 1.0, v10
    v_and_b32 v4, 0x33, v1
    v_bfe_u32 v5, v1, 2, 1
    v_lshl_or_b32 v4, v5, 3, v4
    v_bfe_u32 v5, v1, 3, 1
    v_lshl_or_b32 v4, v5, 2, v4
    v_lshlrev_b32 v66, 4, v4
    v_mov_b32 v72, 0
    v_mov_b32 v73, 0
    v_mov_b32 v74, 0
    v_mov_b32 v75, 0
    v_accvgpr_write_b32 a0, 0
    v_accvgpr_write_b32 a1, 0
    v_accvgpr_write_b32 a2, 0
    v_accvgpr_write_b32 a3, 0
    v_accvgpr_write_b32 a4, 0
    v_accvgpr_write_b32 a5, 0
    v_accvgpr_write_b32 a6, 0
    v_accvgpr_write_b32 a7, 0
    v_accvgpr_write_b32 a8, 0
    v_accvgpr_write_b32 a9, 0
    v_accvgpr_write_b32 a10, 0
    v_accvgpr_write_b32 a11, 0
    v_accvgpr_write_b32 a12, 0
    v_accvgpr_write_b32 a13, 0
    v_accvgpr_write_b32 a14, 0
    v_accvgpr_write_b32 a15, 0
    v_accvgpr_write_b32 a16, 0
    v_accvgpr_write_b32 a17, 0
    v_accvgpr_write_b32 a18, 0
    v_accvgpr_write_b32 a19, 0
    v_accvgpr_write_b32 a20, 0
    v_accvgpr_write_b32 a21, 0
    v_accvgpr_write_b32 a22, 0
    v_accvgpr_write_b32 a23, 0
    v_accvgpr_write_b32 a24, 0
    v_accvgpr_write_b32 a25, 0
    v_accvgpr_write_b32 a26, 0
    v_accvgpr_write_b32 a27, 0
    v_accvgpr_write_b32 a28, 0
    v_accvgpr_write_b32 a29, 0
    v_accvgpr_write_b32 a30, 0
    v_accvgpr_write_b32 a31, 0
    v_accvgpr_write_b32 a32, 0
    v_accvgpr_write_b32 a33, 0
    v_accvgpr_write_b32 a34, 0
    v_accvgpr_write_b32 a35, 0
    v_accvgpr_write_b32 a36, 0
    v_accvgpr_write_b32 a37, 0
    v_accvgpr_write_b32 a38, 0
    v_accvgpr_write_b32 a39, 0
    v_accvgpr_write_b32 a40, 0
    v_accvgpr_write_b32 a41, 0
    v_accvgpr_write_b32 a42, 0
    v_accvgpr_write_b32 a43, 0
    v_accvgpr_write_b32 a44, 0
    v_accvgpr_write_b32 a45, 0
    v_accvgpr_write_b32 a46, 0
    v_accvgpr_write_b32 a47, 0
    v_mov_b32 v32, 0
    v_mov_b32 v33, 0
    v_mov_b32 v34, 0
    v_mov_b32 v35, 0
    v_mov_b32 v36, 0
    v_mov_b32 v37, 0
    v_mov_b32 v38, 0
    v_mov_b32 v39, 0
    v_mov_b32 v40, 0
    v_mov_b32 v41, 0
    v_mov_b32 v42, 0
    v_mov_b32 v43, 0
    v_mov_b32 v44, 0
    v_mov_b32 v45, 0
    v_mov_b32 v46, 0
    v_mov_b32 v47, 0
    s_lshl_b32 s57, s49, 4
    v_and_b32 v3, 31, v1
    s_add_u32 s57, s57, s48
    v_bfe_u32 v4, v3, 2, 2
    s_lshl_b32 s58, s57, 7
    v_and_b32 v5, 1, v3
    s_add_u32 s4, s58, 7471104
    v_lshl_or_b32 v4, v4, 1, v5
    s_add_u32 s6, s58, 7733248
    v_xor_b32 v4, v4, v2
    s_add_u32 s7, s58, 7766016
    v_lshlrev_b32 v4, 3, v4
    s_lshl_b32 s57, s57, 2
    v_bfe_u32 v5, v3, 1, 1
    s_add_u32 s57, s57, s50
    v_lshl_or_b32 v4, v5, 6, v4
    s_lshl_b32 s57, s57, 7
    v_lshl_or_b32 v4, v3, 7, v4
    s_add_u32 s5, s57, 7602176
    v_mul_u32_u24 v31, 896, v3
    s_lshl_b32 s58, s50, 12
    v_lshl_add_u32 v31, v2, 4, v31
    s_add_u32 s58, s58, 8192
    v_add_u32 v56, s58, v4
    v_bfe_u32 v3, v1, 2, 2
    v_lshl_or_b32 v4, v2, 2, v3
    v_lshlrev_b32 v4, 7, v4
    v_bfe_u32 v5, v3, 1, 1
    v_lshl_or_b32 v4, v5, 6, v4
    v_bfe_u32 v5, v1, 4, 1
    v_lshlrev_b32 v5, 2, v5
    v_and_or_b32 v5, v1, 3, v5
    v_lshl_or_b32 v6, v5, 3, v4
    s_and_b32 s57, s50, 1
    v_add_u32 v6, s68, v6
    s_lshl_b32 s57, s57, 6
    v_xor_b32 v27, s57, v6
    v_xor_b32 v28, 64, v27
    v_lshlrev_b32 v6, 9, v2
    v_sub_u32 v29, v27, v6
    v_sub_u32 v30, v28, v6
    v_and_b32 v3, 1, v3
    v_lshl_or_b32 v3, v2, 1, v3
    v_xor_b32 v3, v3, v5
    v_lshl_or_b32 v4, v3, 3, v4
    v_add_u32 v57, s58, v4
    v_xor_b32 v58, 32, v57
    v_xor_b32 v59, 64, v57
    v_xor_b32 v60, 96, v57
    s_mul_i32 s57, s54, 66688
    v_and_b32 v3, 3, v1
    s_lshl_b32 s8, s48, 11
    v_lshlrev_b32 v18, 7, v3
    s_add_u32 s8, s8, s57
    v_lshlrev_b32 v16, 11, v3
    s_add_u32 s8, s8, 7901184
    v_lshrrev_b32 v4, 2, v1
    s_lshl_b32 s57, s50, 6
    v_lshl_add_u32 v4, v4, 6, v3
    s_add_u32 s57, s57, s48
    v_lshlrev_b32 v17, 7, v4
    s_lshl_b32 s57, s57, 7
    v_lshlrev_b32 v9, 2, v1
    s_add_u32 s47, s57, 7471104
    v_mov_b32 v8, 0xdddddddd
    s_lshl_b32 s57, s48, 2
    v_lshrrev_b32 v4, 3, v1
    s_add_u32 s57, s57, s50
    v_mul_u32_u24 v12, 896, v4
    s_mul_i32 s0, s57, 69632
    v_bfe_u32 v3, v1, 4, 1
    s_add_u32 s0, s0, 2752512
    v_lshlrev_b32 v3, 2, v3
    s_lshl_b32 s57, s57, 11
    v_and_b32 v4, 7, v1
    s_add_u32 s60, s57, 7208960
    v_xor_b32 v3, v3, v4
    v_lshl_add_u32 v12, v3, 4, v12
    s_mov_b32 s45, 0x3e8b97f6
    v_add_u32 v13, 6144, v12
    v_add_u32 v14, 12288, v12
    v_add_u32 v15, 18432, v12
    s_min_u32 s69, s61, 27
    s_mul_i32 s56, s69, 37
    s_lshr_b32 s56, s56, 8
    s_mul_i32 s57, s56, 7
    s_sub_u32 s69, s69, s57
    s_and_b32 s57, s2, 7
    s_lshl_b32 s57, s57, 2
    s_add_u32 s56, s56, s57
    s_lshl_b32 s57, s69, 7
    s_mul_i32 s14, s50, 100352
    s_add_u32 s14, s14, s57
    s_lshl_b32 s58, s56, 1
    s_lshr_b32 s59, s50, 1
    s_add_u32 s58, s58, s59
    s_mul_i32 s19, s58, 28672
    s_add_u32 s19, s19, s57
    s_and_b32 s57, s50, 1
    s_lshl_b32 s57, s57, 6
    s_add_u32 s19, s19, s57
    s_mul_i32 s22, s58, 66688
    s_xor_b32 s58, s58, 1
    s_mul_i32 s23, s58, 66688
    s_lshl_b32 s57, s50, 13
    s_add_u32 s57, s57, 7901184
    s_add_u32 s22, s22, s57
    s_add_u32 s23, s23, s57
    s_lshr_b32 s57, s56, 1
    s_lshl_b32 s57, s57, 2
    s_add_u32 s57, s57, s50
    s_lshl_b32 s57, s57, 9
    s_add_u32 s18, s57, 7733248
    s_cmp_lt_u32 s61, 28
    s_cselect_b32 s13, 0x62000, 0
    s_cselect_b32 s15, s68, 196608
    s_lshl_b32 s57, s50, 11
    v_add_u32 v22, s57, v7
    v_add_u32 v19, 147456, v22
    v_add_u32 v22, 114688, v22
    s_lshl_b32 s57, s50, 13
    v_add_u32 v21, s57, v7
    v_add_u32 v21, 114688, v21
    s_mul_i32 s57, s50, 12288
    v_add_u32 v26, s57, v7
    v_add_u32 v26, 114688, v26
    s_xor_b32 s57, s50, 1
    s_mul_i32 s57, s57, 12288
    s_add_u32 s57, s57, 114688
    v_add_u32 v23, s57, v7
    s_xor_b32 s57, s50, 2
    s_mul_i32 s57, s57, 12288
    s_add_u32 s57, s57, 118784
    v_add_u32 v24, s57, v7
    s_xor_b32 s57, s50, 3
    s_mul_i32 s57, s57, 12288
    s_add_u32 s57, s57, 122880
    v_add_u32 v25, s57, v7
    s_cmp_eq_u32 s50, 0
    s_cselect_b32 s4, s4, 0x40000000
    s_cselect_b32 s6, s6, 0x40000000
    s_cselect_b32 s7, s7, 0x40000000
    v_and_b32 v3, 15, v1
    v_mul_u32_u24 v31, 896, v3
    v_lshl_add_u32 v31, v2, 4, v31
    v_bfe_u32 v3, v1, 4, 1
    v_lshl_add_u32 v31, v3, 5, v31
    s_add_u32 s0, s0, s24
    s_addc_u32 s1, s25, 0
    v_and_b32 v3, 31, v1
    v_bfe_u32 v4, v1, 1, 3
    v_xor_b32 v4, v4, v2
    v_lshlrev_b32 v4, 4, v4
    v_lshl_add_u32 v4, v3, 7, v4
    v_add_u32 v104, s68, v4
    v_xor_b32 v105, 32, v104
    v_xor_b32 v106, 64, v104
    v_xor_b32 v107, 96, v104
    v_min_u32 v3, 41, v1
    v_lshlrev_b32 v247, 9, v3
    v_add_u32 v67, 0x10000, v7
    v_add_u32 v68, 0x20000, v7
    s_mov_b32 s69, s51
    s_and_b32 s56, s48, 3
    s_mul_i32 s56, s56, 2
    s_mul_i32 s57, s56, 37
    s_lshr_b32 s57, s57, 8
    s_mul_i32 s57, s57, 7
    s_sub_u32 s56, s56, s57
    s_lshr_b32 s57, s48, 2
    s_lshl_b32 s55, s57, 7
    s_add_u32 s55, s55, 7340032
    s_mul_i32 s53, s44, 688128
    s_mul_i32 s57, s26, 28
    s_add_u32 s57, s57, s27
    s_lshl_b32 s57, s57, 10
    s_add_u32 s53, s53, s57
    s_waitcnt lgkmcnt(0)
    s_add_u32 s64, s12, 1
    s_xor_b32 s65, s64, 0x5bd1e995
    v_mov_b32 v252, s64
    v_mov_b32 v253, s65
    v_mov_b32 v254, s64
    v_mov_b32 v255, s65
    s_cmp_ge_u32 s3, 42
    s_cbranch_scc1 L_np2
    s_waitcnt vmcnt(0)
    ds_read_b64_tr_b16 v[112:113], v108 offset:0
    ds_read_b64_tr_b16 v[114:115], v108 offset:896
    ds_read_b64_tr_b16 v[116:117], v108 offset:56
    ds_read_b64_tr_b16 v[118:119], v108 offset:952
    ds_read_b64_tr_b16 v[120:121], v108 offset:112
    ds_read_b64_tr_b16 v[122:123], v108 offset:1008
    ds_read_b64_tr_b16 v[124:125], v108 offset:168
    ds_read_b64_tr_b16 v[126:127], v108 offset:1064
    s_cmp_eq_u32 s26, 5
    s_cbranch_scc1 L_gate
L_gate_r:
    s_waitcnt lgkmcnt(6)
    buffer_store_dwordx4 v[112:115], v7, s[36:39], s53 offen sc1
    s_add_u32 s53, s53, 172032
    s_waitcnt lgkmcnt(4)
    buffer_store_dwordx4 v[116:119], v7, s[36:39], s53 offen sc1
    s_add_u32 s53, s53, 172032
    s_waitcnt lgkmcnt(2)
    buffer_store_dwordx4 v[120:123], v7, s[36:39], s53 offen sc1
    s_add_u32 s53, s53, 172032
    s_waitcnt lgkmcnt(0)
    buffer_store_dwordx4 v[124:127], v7, s[36:39], s53 offen sc1
L_np2:
    s_lshl_b32 s58, s50, 10
    s_mul_i32 s57, s48, 1568
    s_add_u32 s57, s57, s58
    s_add_u32 s58, s58, 129024
    s_cmp_lt_u32 s50, 2
    s_cselect_b32 m0, s58, 196608
    s_nop 0
    buffer_load_dwordx4 v7, s[40:43], s57 offen lds
    s_lshl_b32 s58, s56, 12
    s_add_u32 m0, s58, s68
    s_lshl_b32 s58, s56, 7
    s_add_u32 s51, s69, s58
    buffer_load_dwordx4 v96, s[28:31], s51 offen offset:0  lds
    buffer_load_dwordx4 v97, s[28:31], s51 offen offset:1024  lds
    buffer_load_dwordx4 v98, s[28:31], s51 offen offset:2048  lds
    buffer_load_dwordx4 v99, s[28:31], s51 offen offset:3072  lds
    s_add_u32 s56, s56, 1
    s_cmp_eq_u32 s56, 7
    s_cselect_b32 s56, 0, s56
    s_lshl_b32 s58, s56, 12
    s_add_u32 m0, s58, s68
    s_lshl_b32 s58, s56, 7
    s_add_u32 s51, s69, s58
    buffer_load_dwordx4 v96, s[28:31], s51 offen offset:0  lds
    buffer_load_dwordx4 v97, s[28:31], s51 offen offset:1024  lds
    buffer_load_dwordx4 v98, s[28:31], s51 offen offset:2048  lds
    buffer_load_dwordx4 v99, s[28:31], s51 offen offset:3072  lds
    s_add_u32 s56, s56, 1
    s_cmp_eq_u32 s56, 7
    s_cselect_b32 s56, 0, s56
    s_lshl_b32 s57, s3, 2
    s_add_u32 s57, s57, s44
    s_lshl_b32 s57, s57, 7
    s_add_u32 s57, s57, 7340032
    s_cmp_eq_u32 s50, 0
    s_cselect_b32 s57, s57, 0x40000000
    s_waitcnt vmcnt(9)
    s_barrier
    s_mov_b64 exec, 0xff
    buffer_store_dwordx4 v[252:255], v7, s[36:39], s57 offen sc1
    s_mov_b64 exec, -1
    s_lshl_b32 s58, s56, 12
    s_add_u32 m0, s58, s68
    s_lshl_b32 s58, s56, 7
    s_add_u32 s51, s69, s58
    buffer_load_dwordx4 v96, s[28:31], s51 offen offset:0  lds
    buffer_load_dwordx4 v97, s[28:31], s51 offen offset:1024  lds
    buffer_load_dwordx4 v98, s[28:31], s51 offen offset:2048  lds
    buffer_load_dwordx4 v99, s[28:31], s51 offen offset:3072  lds
    s_add_u32 s56, s56, 1
    s_cmp_eq_u32 s56, 7
    s_cselect_b32 s56, 0, s56
    s_lshl_b32 s58, s56, 12
    s_add_u32 m0, s58, s68
    s_lshl_b32 s58, s56, 7
    s_add_u32 s51, s69, s58
    buffer_load_dwordx4 v96, s[28:31], s51 offen offset:0  lds
    buffer_load_dwordx4 v97, s[28:31], s51 offen offset:1024  lds
    buffer_load_dwordx4 v98, s[28:31], s51 offen offset:2048  lds
    buffer_load_dwordx4 v99, s[28:31], s51 offen offset:3072  lds
    s_add_u32 s56, s56, 1
    s_cmp_eq_u32 s56, 7
    s_cselect_b32 s56, 0, s56
    s_lshl_b32 s58, s56, 12
    s_add_u32 m0, s58, s68
    s_lshl_b32 s58, s56, 7
    s_add_u32 s51, s69, s58
    buffer_load_dwordx4 v96, s[28:31], s51 offen offset:0  lds
    buffer_load_dwordx4 v97, s[28:31], s51 offen offset:1024  lds
    buffer_load_dwordx4 v98, s[28:31], s51 offen offset:2048  lds
    buffer_load_dwordx4 v99, s[28:31], s51 offen offset:3072  lds
    s_add_u32 s56, s56, 1
    s_cmp_eq_u32 s56, 7
    s_cselect_b32 s56, 0, s56
    s_lshl_b32 s58, s56, 12
    s_add_u32 m0, s58, s68
    s_lshl_b32 s58, s56, 7
    s_add_u32 s51, s69, s58
    buffer_load_dwordx4 v96, s[28:31], s51 offen offset:0  lds
    buffer_load_dwordx4 v97, s[28:31], s51 offen offset:1024  lds
    buffer_load_dwordx4 v98, s[28:31], s51 offen offset:2048  lds
    buffer_load_dwordx4 v99, s[28:31], s51 offen offset:3072  lds
    s_add_u32 s56, s56, 1
    s_cmp_eq_u32 s56, 7
    s_cselect_b32 s56, 0, s56
    s_lshl_b32 s58, s56, 12
    s_add_u32 m0, s58, s68
    s_lshl_b32 s58, s56, 7
    s_add_u32 s51, s69, s58
    buffer_load_dwordx4 v96, s[28:31], s51 offen offset:0  lds
    buffer_load_dwordx4 v97, s[28:31], s51 offen offset:1024  lds
    buffer_load_dwordx4 v98, s[28:31], s51 offen offset:2048  lds
    buffer_load_dwordx4 v99, s[28:31], s51 offen offset:3072  lds
    s_mul_i32 s52, s48, 172032
    s_lshl_b32 s57, s50, 12
    s_add_u32 s52, s52, s57
    s_add_u32 s52, s52, s24
    s_addc_u32 s53, s25, 0
    s_mov_b32 m0, s57
    s_cmp_eq_u32 s50, 0
    s_cselect_b64 exec, -1, 1
    s_waitcnt vmcnt(4)
    buffer_load_dwordx2 v[248:249], v247, s[36:39], s55 offen sc1
    s_mov_b64 exec, -1
    s_waitcnt vmcnt(1)
    ds_read_b128 a[128:131], v104 offset:0
    ds_read_b128 a[132:135], v105 offset:0
    ds_read_b128 a[136:139], v106 offset:0
    ds_read_b128 a[140:143], v107 offset:0
    ds_read_b128 a[144:147], v104 offset:4096
    ds_read_b128 a[148:151], v105 offset:4096
    ds_read_b128 a[152:155], v106 offset:4096
    ds_read_b128 a[156:159], v107 offset:4096
    ds_read_b128 a[160:163], v104 offset:8192
    ds_read_b128 a[164:167], v105 offset:8192
    ds_read_b128 a[168:171], v106 offset:8192
    ds_read_b128 a[172:175], v107 offset:8192
    s_waitcnt lgkmcnt(0)
    ds_read_b128 a[176:179], v104 offset:12288
    ds_read_b128 a[180:183], v105 offset:12288
    ds_read_b128 a[184:187], v106 offset:12288
    ds_read_b128 a[188:191], v107 offset:12288
    ds_read_b128 a[192:195], v104 offset:16384
    ds_read_b128 a[196:199], v105 offset:16384
    ds_read_b128 a[200:203], v106 offset:16384
    ds_read_b128 a[204:207], v107 offset:16384
    ds_read_b128 a[208:211], v104 offset:20480
    ds_read_b128 a[212:215], v105 offset:20480
    ds_read_b128 a[216:219], v106 offset:20480
    ds_read_b128 a[220:223], v107 offset:20480
    s_waitcnt lgkmcnt(0)
    ds_read_b128 a[224:227], v104 offset:24576
    ds_read_b128 a[228:231], v105 offset:24576
    ds_read_b128 a[232:235], v106 offset:24576
    ds_read_b128 a[236:239], v107 offset:24576
    s_cmp_lg_u32 s50, 0
    s_cbranch_scc1 L_pw_ok
    s_waitcnt vmcnt(0)
    v_cmp_ne_u64 vcc, s[64:65], v[248:249]
    s_cbranch_vccnz L_pw_s
L_pw_ok:
    s_waitcnt vmcnt(0)
    s_waitcnt lgkmcnt(0)
    s_barrier
    global_load_lds_dwordx4 v7, s[52:53] offset:0 sc1
    global_load_lds_dwordx4 v7, s[52:53] offset:1024 sc1
    global_load_lds_dwordx4 v7, s[52:53] offset:2048 sc1
    global_load_lds_dwordx4 v7, s[52:53] offset:3072 sc1
    s_add_u32 m0, m0, 16384
    s_add_u32 s52, s52, 16384
    s_addc_u32 s53, s53, 0
    global_load_lds_dwordx4 v7, s[52:53] offset:0 sc1
    global_load_lds_dwordx4 v7, s[52:53] offset:1024 sc1
    global_load_lds_dwordx4 v7, s[52:53] offset:2048 sc1
    global_load_lds_dwordx4 v7, s[52:53] offset:3072 sc1
    s_add_u32 m0, m0, 16384
    s_add_u32 s52, s52, 16384
    s_addc_u32 s53, s53, 0
    global_load_lds_dwordx4 v7, s[52:53] offset:0 sc1
    global_load_lds_dwordx4 v7, s[52:53] offset:1024 sc1
    s_mov_b32 s27, 0x3fb8aa3b
    s_waitcnt vmcnt(6)
    s_barrier
    ds_read_b128 a[240:243], v7 offset:0
    ds_read_b128 a[244:247], v7 offset:1024
    ds_read_b128 a[248:251], v7 offset:2048
    s_waitcnt lgkmcnt(2)
    v_mfma_f32_32x32x16_bf16 v[128:143], a[240:243], a[128:131], 0
    s_waitcnt lgkmcnt(1)
    ds_read_b128 a[252:255], v7 offset:3072
    v_mfma_f32_32x32x16_bf16 v[128:143], a[244:247], a[132:135], v[128:143]
    s_waitcnt lgkmcnt(1)
    ds_read_b128 a[240:243], v7 offset:4096
    global_load_lds_dwordx4 v7, s[52:53] offset:2048 sc1
    v_mfma_f32_32x32x16_bf16 v[128:143], a[248:251], a[136:139], v[128:143]
    s_waitcnt lgkmcnt(1)
    ds_read_b128 a[244:247], v7 offset:5120
    ds_read_b64_tr_b16 a[48:49], v92 offset:0
    v_mfma_f32_32x32x16_bf16 v[128:143], a[252:255], a[140:143], v[128:143]
    s_waitcnt lgkmcnt(2)
    ds_read_b128 a[248:251], v7 offset:6144
    ds_read_b64_tr_b16 a[50:51], v92 offset:448
    v_mfma_f32_32x32x16_bf16 v[128:143], a[240:243], a[144:147], v[128:143]
    s_waitcnt lgkmcnt(3)
    ds_read_b128 a[252:255], v7 offset:7168
    ds_read_b64_tr_b16 a[52:53], v92 offset:896
    v_mfma_f32_32x32x16_bf16 v[128:143], a[244:247], a[148:151], v[128:143]
    s_waitcnt lgkmcnt(3)
    ds_read_b128 a[240:243], v7 offset:8192
    global_load_lds_dwordx4 v7, s[52:53] offset:3072 sc1
    s_add_u32 m0, m0, 16384
    s_add_u32 s52, s52, 16384
    s_addc_u32 s53, s53, 0
    ds_read_b64_tr_b16 a[54:55], v92 offset:1344
    v_mfma_f32_32x32x16_bf16 v[128:143], a[248:251], a[152:155], v[128:143]
    s_waitcnt lgkmcnt(3)
    ds_read_b128 a[244:247], v7 offset:9216
    v_mfma_f32_32x32x16_bf16 v[128:143], a[252:255], a[156:159], v[128:143]
    s_waitcnt lgkmcnt(2)
    ds_read_b128 a[248:251], v7 offset:10240
    v_mfma_f32_32x32x16_bf16 v[128:143], a[240:243], a[160:163], v[128:143]
    s_waitcnt lgkmcnt(1)
    ds_read_b128 a[252:255], v7 offset:11264
    v_mfma_f32_32x32x16_bf16 v[128:143], a[244:247], a[164:167], v[128:143]
    s_waitcnt lgkmcnt(1)
    ds_read_b128 a[240:243], v7 offset:12288
    global_load_lds_dwordx4 v7, s[52:53] offset:0 sc1
    v_mfma_f32_32x32x16_bf16 v[128:143], a[248:251], a[168:171], v[128:143]
    s_waitcnt lgkmcnt(1)
    ds_read_b128 a[244:247], v7 offset:13312
    v_mfma_f32_32x32x16_bf16 v[128:143], a[252:255], a[172:175], v[128:143]
    s_waitcnt lgkmcnt(1)
    ds_read_b128 a[248:251], v7 offset:14336
    v_mfma_f32_32x32x16_bf16 v[128:143], a[240:243], a[176:179], v[128:143]
    s_waitcnt lgkmcnt(1)
    ds_read_b128 a[252:255], v7 offset:15360
    v_mfma_f32_32x32x16_bf16 v[128:143], a[244:247], a[180:183], v[128:143]
    s_waitcnt vmcnt(5) lgkmcnt(1)
    s_barrier
    ds_read_b128 a[240:243], v7 offset:16384
    global_load_lds_dwordx4 v7, s[52:53] offset:1024 sc1
    v_mfma_f32_32x32x16_bf16 v[128:143], a[248:251], a[184:187], v[128:143]
    s_waitcnt lgkmcnt(1)
    ds_read_b128 a[244:247], v7 offset:17408
    v_mfma_f32_32x32x16_bf16 v[128:143], a[252:255], a[188:191], v[128:143]
    s_waitcnt lgkmcnt(1)
    ds_read_b128 a[248:251], v7 offset:18432
    v_mfma_f32_32x32x16_bf16 v[128:143], a[240:243], a[192:195], v[128:143]
    s_waitcnt lgkmcnt(1)
    ds_read_b128 a[252:255], v7 offset:19456
    v_mfma_f32_32x32x16_bf16 v[128:143], a[244:247], a[196:199], v[128:143]
    s_waitcnt lgkmcnt(1)
    ds_read_b128 a[240:243], v7 offset:20480
    global_load_lds_dwordx4 v7, s[52:53] offset:2048 sc1
    v_mfma_f32_32x32x16_bf16 v[128:143], a[248:251], a[200:203], v[128:143]
    s_waitcnt lgkmcnt(1)
    ds_read_b128 a[244:247], v7 offset:21504
    v_mfma_f32_32x32x16_bf16 v[128:143], a[252:255], a[204:207], v[128:143]
    s_waitcnt lgkmcnt(1)
    ds_read_b128 a[248:251], v7 offset:22528
    v_mfma_f32_32x32x16_bf16 v[128:143], a[240:243], a[208:211], v[128:143]
    s_waitcnt lgkmcnt(1)
    ds_read_b128 a[252:255], v7 offset:23552
    v_mfma_f32_32x32x16_bf16 v[128:143], a[244:247], a[212:215], v[128:143]
    s_waitcnt lgkmcnt(1)
    ds_read_b128 a[240:243], v7 offset:24576
    global_load_lds_dwordx4 v7, s[52:53] offset:3072 sc1
    s_add_u32 m0, m0, 16384
    s_add_u32 s52, s52, 16384
    s_addc_u32 s53, s53, 0
    v_mfma_f32_32x32x16_bf16 v[128:143], a[248:251], a[216:219], v[128:143]
    s_waitcnt lgkmcnt(1)
    ds_read_b128 a[244:247], v7 offset:25600
    v_mfma_f32_32x32x16_bf16 v[128:143], a[252:255], a[220:223], v[128:143]
    s_waitcnt lgkmcnt(1)
    ds_read_b128 a[248:251], v7 offset:26624
    v_mfma_f32_32x32x16_bf16 v[128:143], a[240:243], a[224:227], v[128:143]
    s_waitcnt lgkmcnt(1)
    ds_read_b128 a[252:255], v7 offset:27648
    v_mfma_f32_32x32x16_bf16 v[128:143], a[244:247], a[228:231], v[128:143]
    s_waitcnt lgkmcnt(1)
    ds_read_b128 a[240:243], v7 offset:28672
    global_load_lds_dwordx4 v7, s[52:53] offset:0 sc1
    v_mfma_f32_32x32x16_bf16 v[128:143], a[248:251], a[232:235], v[128:143]
    s_waitcnt lgkmcnt(1)
    ds_read_b128 a[244:247], v7 offset:29696
    v_mfma_f32_32x32x16_bf16 v[128:143], a[252:255], a[236:239], v[128:143]
    s_waitcnt lgkmcnt(1)
    ds_read_b128 a[248:251], v7 offset:30720
    v_mfma_f32_32x32x16_bf16 v[96:111], a[240:243], a[128:131], 0
    s_waitcnt lgkmcnt(1)
    ds_read_b128 a[252:255], v7 offset:31744
    v_mfma_f32_32x32x16_bf16 v[96:111], a[244:247], a[132:135], v[96:111]
    s_waitcnt vmcnt(5) lgkmcnt(1)
    s_barrier
    ds_read_b128 a[240:243], v7 offset:32768
    global_load_lds_dwordx4 v7, s[52:53] offset:1024 sc1
    v_mfma_f32_32x32x16_bf16 v[96:111], a[248:251], a[136:139], v[96:111]
    s_waitcnt lgkmcnt(1)
    ds_read_b128 a[244:247], v7 offset:33792
    v_cvt_pk_bf16_f32 v128, v128, v129
    v_cvt_pk_bf16_f32 v129, v130, v131
    v_cvt_pk_bf16_f32 v130, v132, v133
    v_cvt_pk_bf16_f32 v131, v134, v135
    v_cvt_pk_bf16_f32 v132, v136, v137
    v_mfma_f32_32x32x16_bf16 v[96:111], a[252:255], a[140:143], v[96:111]
    s_waitcnt lgkmcnt(1)
    ds_read_b128 a[248:251], v7 offset:34816
    v_cvt_pk_bf16_f32 v133, v138, v139
    v_cvt_pk_bf16_f32 v134, v140, v141
    v_cvt_pk_bf16_f32 v135, v142, v143
    v_and_b32 v134, v134, v10
    v_and_b32 v135, v135, v10
    v_mfma_f32_32x32x16_bf16 v[96:111], a[240:243], a[144:147], v[96:111]
    s_waitcnt lgkmcnt(1)
    ds_read_b128 a[252:255], v7 offset:35840
    v_mfma_f32_32x32x16_bf16 v[76:91], a[48:51], v[128:131], 0
    v_mfma_f32_32x32x16_bf16 v[76:91], a[52:55], v[132:135], v[76:91]
    v_mfma_f32_32x32x16_bf16 v[96:111], a[244:247], a[148:151], v[96:111]
    s_waitcnt lgkmcnt(1)
    ds_read_b128 a[240:243], v7 offset:36864
    global_load_lds_dwordx4 v7, s[52:53] offset:2048 sc1
    v_mfma_f32_32x32x16_bf16 v[96:111], a[248:251], a[152:155], v[96:111]
    s_waitcnt lgkmcnt(1)
    ds_read_b128 a[244:247], v7 offset:37888
    v_mfma_f32_32x32x16_bf16 v[96:111], a[252:255], a[156:159], v[96:111]
    s_waitcnt lgkmcnt(1)
    ds_read_b128 a[248:251], v7 offset:38912
    v_mfma_f32_32x32x16_bf16 v[96:111], a[240:243], a[160:163], v[96:111]
    s_waitcnt lgkmcnt(1)
    ds_read_b128 a[252:255], v7 offset:39936
    v_cvt_pk_bf16_f32 v192, v76, v77
    v_cvt_pk_bf16_f32 v193, v78, v79
    v_cvt_pk_bf16_f32 v194, v80, v81
    v_cvt_pk_bf16_f32 v195, v82, v83
    v_cvt_pk_bf16_f32 v196, v84, v85
    v_mfma_f32_32x32x16_bf16 v[96:111], a[244:247], a[164:167], v[96:111]
    s_waitcnt lgkmcnt(1)
    ds_read_b128 a[240:243], v7 offset:40960
    global_load_lds_dwordx4 v7, s[52:53] offset:3072 sc1
    s_add_u32 m0, m0, 16384
    s_add_u32 s52, s52, 16384
    s_addc_u32 s53, s53, 0
    v_cvt_pk_bf16_f32 v197, v86, v87
    v_cvt_pk_bf16_f32 v198, v88, v89
    v_mfma_f32_32x32x16_bf16 v[96:111], a[248:251], a[168:171], v[96:111]
    s_waitcnt lgkmcnt(1)
    ds_read_b128 a[244:247], v7 offset:41984
    v_cvt_pk_bf16_f32 v199, v90, v91
    v_lshlrev_b32 v76, 16, v192
    v_and_b32 v77, 0xffff0000, v192
    v_lshlrev_b32 v78, 16, v193
    v_and_b32 v79, 0xffff0000, v193
    v_mfma_f32_32x32x16_bf16 v[96:111], a[252:255], a[172:175], v[96:111]
    s_waitcnt lgkmcnt(1)
    ds_read_b128 a[248:251], v7 offset:43008
    v_lshlrev_b32 v80, 16, v194
    v_and_b32 v81, 0xffff0000, v194
    v_lshlrev_b32 v82, 16, v195
    v_and_b32 v83, 0xffff0000, v195
    v_lshlrev_b32 v84, 16, v196
    v_mfma_f32_32x32x16_bf16 v[96:111], a[240:243], a[176:179], v[96:111]
    s_waitcnt lgkmcnt(1)
    ds_read_b128 a[252:255], v7 offset:44032
    v_and_b32 v85, 0xffff0000, v196
    v_lshlrev_b32 v86, 16, v197
    v_and_b32 v87, 0xffff0000, v197
    v_lshlrev_b32 v88, 16, v198
    v_and_b32 v89, 0xffff0000, v198
    v_mfma_f32_32x32x16_bf16 v[96:111], a[244:247], a[180:183], v[96:111]
    s_waitcnt lgkmcnt(1)
    ds_read_b128 a[240:243], v7 offset:45056
    global_load_lds_dwordx4 v7, s[52:53] offset:0 sc1
    v_lshlrev_b32 v90, 16, v199
    v_and_b32 v91, 0xffff0000, v199
    v_mfma_f32_32x32x16_bf16 v[96:111], a[248:251], a[184:187], v[96:111]
    s_waitcnt lgkmcnt(1)
    ds_read_b128 a[244:247], v7 offset:46080
    v_max3_f32 v48, v76, v77, v78
    v_min3_f32 v49, v76, v77, v78
    v_max3_f32 v48, v48, v79, v80
    v_min3_f32 v49, v49, v79, v80
    v_max3_f32 v48, v48, v81, v82
    v_mfma_f32_32x32x16_bf16 v[96:111], a[252:255], a[188:191], v[96:111]
    s_waitcnt lgkmcnt(1)
    ds_read_b128 a[248:251], v7 offset:47104
    v_min3_f32 v49, v49, v81, v82
    v_max3_f32 v48, v48, v83, v84
    v_min3_f32 v49, v49, v83, v84
    v_max3_f32 v48, v48, v85, v86
    v_min3_f32 v49, v49, v85, v86
    v_mfma_f32_32x32x16_bf16 v[96:111], a[240:243], a[192:195], v[96:111]
    s_waitcnt lgkmcnt(1)
    ds_read_b128 a[252:255], v7 offset:48128
    v_max3_f32 v48, v48, v87, v88
    v_min3_f32 v49, v49, v87, v88
    v_max3_f32 v48, v48, v89, v90
    v_min3_f32 v49, v49, v89, v90
    v_max_f32 v48, v48, v91
    v_mfma_f32_32x32x16_bf16 v[96:111], a[244:247], a[196:199], v[96:111]
    s_waitcnt vmcnt(5) lgkmcnt(1)
    s_barrier
    ds_read_b128 a[240:243], v7 offset:49152
    global_load_lds_dwordx4 v7, s[52:53] offset:1024 sc1
    v_min_f32 v49, v49, v91
    v_mov_b32 v50, v48
    v_mfma_f32_32x32x16_bf16 v[96:111], a[248:251], a[200:203], v[96:111]
    s_waitcnt lgkmcnt(1)
    ds_read_b128 a[244:247], v7 offset:50176
    v_mov_b32 v51, v49
    v_mfma_f32_32x32x16_bf16 v[96:111], a[252:255], a[204:207], v[96:111]
    s_waitcnt lgkmcnt(1)
    ds_read_b128 a[248:251], v7 offset:51200
    v_permlane32_swap_b32 v50, v48
    v_permlane32_swap_b32 v51, v49
    v_max_f32 v48, v48, v50
    v_min_f32 v49, v49, v51
    v_mul_f32 v48, s27, v48
    v_mfma_f32_32x32x16_bf16 v[96:111], a[240:243], a[208:211], v[96:111]
    s_waitcnt lgkmcnt(1)
    ds_read_b128 a[252:255], v7 offset:52224
    v_mul_f32 v49, s27, v49
    v_fma_f32 v192, v76, s27, -v48
    v_fma_f32 v208, -v76, s27, v49
    v_fma_f32 v193, v77, s27, -v48
    v_fma_f32 v209, -v77, s27, v49
    v_mfma_f32_32x32x16_bf16 v[96:111], a[244:247], a[212:215], v[96:111]
    s_waitcnt lgkmcnt(1)
    ds_read_b128 a[240:243], v7 offset:53248
    global_load_lds_dwordx4 v7, s[52:53] offset:2048 sc1
    v_fma_f32 v194, v78, s27, -v48
    v_fma_f32 v210, -v78, s27, v49
    v_mfma_f32_32x32x16_bf16 v[96:111], a[248:251], a[216:219], v[96:111]
    s_waitcnt lgkmcnt(1)
    ds_read_b128 a[244:247], v7 offset:54272
    v_fma_f32 v195, v79, s27, -v48
    v_fma_f32 v211, -v79, s27, v49
    v_fma_f32 v196, v80, s27, -v48
    v_fma_f32 v212, -v80, s27, v49
    v_fma_f32 v197, v81, s27, -v48
    v_mfma_f32_32x32x16_bf16 v[96:111], a[252:255], a[220:223], v[96:111]
    s_waitcnt lgkmcnt(1)
    ds_read_b128 a[248:251], v7 offset:55296
    v_fma_f32 v213, -v81, s27, v49
    v_fma_f32 v198, v82, s27, -v48
    v_fma_f32 v214, -v82, s27, v49
    v_fma_f32 v199, v83, s27, -v48
    v_fma_f32 v215, -v83, s27, v49
    v_mfma_f32_32x32x16_bf16 v[96:111], a[240:243], a[224:227], v[96:111]
    s_waitcnt lgkmcnt(1)
    ds_read_b128 a[252:255], v7 offset:56320
    v_fma_f32 v200, v84, s27, -v48
    v_fma_f32 v216, -v84, s27, v49
    v_fma_f32 v201, v85, s27, -v48
    v_fma_f32 v217, -v85, s27, v49
    v_fma_f32 v202, v86, s27, -v48
    v_mfma_f32_32x32x16_bf16 v[96:111], a[244:247], a[228:231], v[96:111]
    s_waitcnt lgkmcnt(1)
    ds_read_b128 a[240:243], v7 offset:57344
    global_load_lds_dwordx4 v7, s[52:53] offset:3072 sc1
    s_add_u32 m0, m0, 16384
    s_add_u32 s52, s52, 16384
    s_addc_u32 s53, s53, 0
    v_fma_f32 v218, -v86, s27, v49
    v_fma_f32 v203, v87, s27, -v48
    v_mfma_f32_32x32x16_bf16 v[96:111], a[248:251], a[232:235], v[96:111]
    s_waitcnt lgkmcnt(1)
    ds_read_b128 a[244:247], v7 offset:58368
    v_fma_f32 v219, -v87, s27, v49
    v_fma_f32 v204, v88, s27, -v48
    v_fma_f32 v220, -v88, s27, v49
    v_fma_f32 v205, v89, s27, -v48
    v_fma_f32 v221, -v89, s27, v49
    v_mfma_f32_32x32x16_bf16 v[96:111], a[252:255], a[236:239], v[96:111]
    s_waitcnt lgkmcnt(1)
    ds_read_b128 a[248:251], v7 offset:59392
    v_fma_f32 v206, v90, s27, -v48
    v_fma_f32 v222, -v90, s27, v49
    v_fma_f32 v207, v91, s27, -v48
    v_fma_f32 v223, -v91, s27, v49
    v_mfma_f32_32x32x16_bf16 v[112:127], a[128:131], a[240:243], 0
    s_waitcnt lgkmcnt(1)
    ds_read_b128 a[252:255], v7 offset:60416
    v_exp_f32 v192, v192
    v_exp_f32 v208, v208
    v_mfma_f32_32x32x16_bf16 v[112:127], a[132:135], a[244:247], v[112:127]
    s_waitcnt lgkmcnt(1)
    ds_read_b128 a[240:243], v7 offset:61440
    global_load_lds_dwordx4 v7, s[52:53] offset:0 sc1
    v_cvt_pk_bf16_f32 v96, v96, v97
    v_cvt_pk_bf16_f32 v97, v98, v99
    v_mfma_f32_32x32x16_bf16 v[112:127], a[136:139], a[248:251], v[112:127]
    s_waitcnt lgkmcnt(1)
    ds_read_b128 a[244:247], v7 offset:62464
    v_cvt_pk_bf16_f32 v98, v100, v101
    v_cvt_pk_bf16_f32 v99, v102, v103
    v_cvt_pk_bf16_f32 v100, v104, v105
    v_cvt_pk_bf16_f32 v101, v106, v107
    v_cvt_pk_bf16_f32 v102, v108, v109
    v_mfma_f32_32x32x16_bf16 v[112:127], a[140:143], a[252:255], v[112:127]
    s_waitcnt lgkmcnt(1)
    ds_read_b128 a[248:251], v7 offset:63488
    v_cvt_pk_bf16_f32 v103, v110, v111
    v_and_or_b32 v102, v102, v10, v63
    v_and_or_b32 v103, v103, v10, v64
    v_exp_f32 v193, v193
    v_mfma_f32_32x32x16_bf16 v[112:127], a[144:147], a[240:243], v[112:127]
    s_waitcnt lgkmcnt(1)
    ds_read_b128 a[252:255], v7 offset:64512
    buffer_store_dwordx4 v[96:99], v66, s[36:39], s46 offen sc1
    v_exp_f32 v209, v209
    v_mfma_f32_32x32x16_bf16 v[112:127], a[148:151], a[244:247], v[112:127]
    s_waitcnt vmcnt(6) lgkmcnt(1)
    s_barrier
    ds_read_b128 a[240:243], v67 offset:0
    global_load_lds_dwordx4 v7, s[52:53] offset:1024 sc1
    v_exp_f32 v194, v194
    v_mfma_f32_32x32x16_bf16 v[112:127], a[152:155], a[248:251], v[112:127]
    s_waitcnt lgkmcnt(1)
    ds_read_b128 a[244:247], v67 offset:1024
    buffer_store_dwordx4 v[100:103], v66, s[36:39], s46 offen offset:1024 sc1
    v_exp_f32 v210, v210
    v_mfma_f32_32x32x16_bf16 v[112:127], a[156:159], a[252:255], v[112:127]
    s_waitcnt lgkmcnt(1)
    ds_read_b128 a[248:251], v67 offset:2048
    s_mov_b64 exec, 0xff
    buffer_store_dwordx4 v[72:75], v7, s[36:39], s9 offen sc1
    s_mov_b64 exec, -1
    s_mov_b32 s43, 0x00020000
    s_mov_b32 s40, s20
    v_mfma_f32_32x32x16_bf16 v[112:127], a[160:163], a[240:243], v[112:127]
    s_waitcnt lgkmcnt(1)
    s_mov_b32 s41, s21
    ds_read_b128 a[252:255], v67 offset:3072
    s_mov_b32 s42, 0x1c0000
    s_add_u32 s28, s10, s14
    s_addc_u32 s29, s11, 0
    s_add_u32 s30, s16, s14
    s_addc_u32 s31, s17, 0
    v_mfma_f32_32x32x16_bf16 v[112:127], a[164:167], a[244:247], v[112:127]
    s_waitcnt lgkmcnt(1)
    ds_read_b128 a[240:243], v67 offset:4096
    global_load_lds_dwordx4 v7, s[52:53] offset:2048 sc1
    v_exp_f32 v195, v195
    v_mfma_f32_32x32x16_bf16 v[112:127], a[168:171], a[248:251], v[112:127]
    s_waitcnt lgkmcnt(1)
    ds_read_b128 a[244:247], v67 offset:5120
    v_exp_f32 v211, v211
    v_exp_f32 v196, v196
    v_mfma_f32_32x32x16_bf16 v[112:127], a[172:175], a[252:255], v[112:127]
    s_waitcnt lgkmcnt(1)
    ds_read_b128 a[248:251], v67 offset:6144
    v_exp_f32 v212, v212
    v_exp_f32 v197, v197
    v_mfma_f32_32x32x16_bf16 v[112:127], a[176:179], a[240:243], v[112:127]
    s_waitcnt lgkmcnt(1)
    ds_read_b128 a[252:255], v67 offset:7168
    v_exp_f32 v213, v213
    v_exp_f32 v198, v198
    v_mfma_f32_32x32x16_bf16 v[112:127], a[180:183], a[244:247], v[112:127]
    s_waitcnt lgkmcnt(1)
    ds_read_b128 a[240:243], v67 offset:8192
    global_load_lds_dwordx4 v7, s[52:53] offset:3072 sc1
    s_add_u32 m0, m0, 16384
    s_add_u32 s52, s52, 16384
    s_addc_u32 s53, s53, 0
    v_exp_f32 v214, v214
    v_mfma_f32_32x32x16_bf16 v[112:127], a[184:187], a[248:251], v[112:127]
    s_waitcnt lgkmcnt(1)
    ds_read_b128 a[244:247], v67 offset:9216
    v_exp_f32 v199, v199
    v_exp_f32 v215, v215
    v_mfma_f32_32x32x16_bf16 v[112:127], a[188:191], a[252:255], v[112:127]
    s_waitcnt lgkmcnt(1)
    ds_read_b128 a[248:251], v67 offset:10240
    v_exp_f32 v200, v200
    v_exp_f32 v216, v216
    v_mfma_f32_32x32x16_bf16 v[112:127], a[192:195], a[240:243], v[112:127]
    s_waitcnt lgkmcnt(1)
    ds_read_b128 a[252:255], v67 offset:11264
    v_exp_f32 v201, v201
    v_exp_f32 v217, v217
    v_mfma_f32_32x32x16_bf16 v[112:127], a[196:199], a[244:247], v[112:127]
    s_waitcnt lgkmcnt(1)
    ds_read_b128 a[240:243], v67 offset:12288
    global_load_lds_dwordx4 v7, s[52:53] offset:0 sc1
    v_exp_f32 v202, v202
    v_mfma_f32_32x32x16_bf16 v[112:127], a[200:203], a[248:251], v[112:127]
    s_waitcnt lgkmcnt(1)
    ds_read_b128 a[244:247], v67 offset:13312
    v_exp_f32 v218, v218
    v_exp_f32 v203, v203
    v_mfma_f32_32x32x16_bf16 v[112:127], a[204:207], a[252:255], v[112:127]
    s_waitcnt lgkmcnt(1)
    ds_read_b128 a[248:251], v67 offset:14336
    v_exp_f32 v219, v219
    v_exp_f32 v204, v204
    v_mfma_f32_32x32x16_bf16 v[112:127], a[208:211], a[240:243], v[112:127]
    s_waitcnt lgkmcnt(1)
    ds_read_b128 a[252:255], v67 offset:15360
    v_exp_f32 v220, v220
    v_exp_f32 v205, v205
    v_mfma_f32_32x32x16_bf16 v[112:127], a[212:215], a[244:247], v[112:127]
    s_waitcnt vmcnt(8) lgkmcnt(1)
    s_barrier
    ds_read_b128 a[240:243], v67 offset:16384
    global_load_lds_dwordx4 v7, s[52:53] offset:1024 sc1
    v_exp_f32 v221, v221
    v_mfma_f32_32x32x16_bf16 v[112:127], a[216:219], a[248:251], v[112:127]
    s_waitcnt lgkmcnt(1)
    ds_read_b128 a[244:247], v67 offset:17408
    v_exp_f32 v206, v206
    v_exp_f32 v222, v222
    v_mfma_f32_32x32x16_bf16 v[112:127], a[220:223], a[252:255], v[112:127]
    s_waitcnt lgkmcnt(1)
    ds_read_b128 a[248:251], v67 offset:18432
    v_exp_f32 v207, v207
    v_exp_f32 v223, v223
    v_add_f32 v52, v192, v193
    v_mfma_f32_32x32x16_bf16 v[112:127], a[224:227], a[240:243], v[112:127]
    s_waitcnt lgkmcnt(1)
    ds_read_b128 a[252:255], v67 offset:19456
    v_add_f32 v54, v208, v209
    v_mul_f32 v204, v65, v204
    v_mul_f32 v220, v65, v220
    v_mul_f32 v205, v65, v205
    v_mul_f32 v221, v65, v221
    v_mfma_f32_32x32x16_bf16 v[112:127], a[228:231], a[244:247], v[112:127]
    s_waitcnt lgkmcnt(1)
    ds_read_b128 a[240:243], v67 offset:20480
    global_load_lds_dwordx4 v7, s[52:53] offset:2048 sc1
    v_mul_f32 v206, v65, v206
    v_mul_f32 v222, v65, v222
    v_mfma_f32_32x32x16_bf16 v[112:127], a[232:235], a[248:251], v[112:127]
    s_waitcnt lgkmcnt(1)
    ds_read_b128 a[244:247], v67 offset:21504
    v_mul_f32 v207, v65, v207
    v_mul_f32 v223, v65, v223
    v_add_f32 v52, v52, v194
    v_add_f32 v54, v54, v210
    v_add_f32 v52, v52, v195
    v_mfma_f32_32x32x16_bf16 v[112:127], a[236:239], a[252:255], v[112:127]
    s_waitcnt lgkmcnt(1)
    ds_read_b128 a[248:251], v67 offset:22528
    v_add_f32 v54, v54, v211
    v_add_f32 v52, v52, v196
    v_add_f32 v54, v54, v212
    v_add_f32 v52, v52, v197
    v_add_f32 v54, v54, v213
    v_mfma_f32_32x32x16_bf16 v[144:159], a[240:243], a[128:131], 0
    s_waitcnt lgkmcnt(1)
    ds_read_b128 a[252:255], v67 offset:23552
    v_add_f32 v52, v52, v198
    v_add_f32 v54, v54, v214
    v_add_f32 v52, v52, v199
    v_add_f32 v54, v54, v215
    v_add_f32 v52, v52, v200
    v_mfma_f32_32x32x16_bf16 v[144:159], a[244:247], a[132:135], v[144:159]
    s_waitcnt lgkmcnt(1)
    ds_read_b128 a[240:243], v67 offset:24576
    global_load_lds_dwordx4 v7, s[52:53] offset:3072 sc1
    s_add_u32 m0, m0, 16384
    s_add_u32 s52, s52, 16384
    s_addc_u32 s53, s53, 0
    v_cvt_pk_bf16_f32 v112, v112, v113
    v_cvt_pk_bf16_f32 v113, v114, v115
    v_mfma_f32_32x32x16_bf16 v[144:159], a[248:251], a[136:139], v[144:159]
    s_waitcnt lgkmcnt(1)
    ds_read_b128 a[244:247], v67 offset:25600
    v_cvt_pk_bf16_f32 v114, v116, v117
    v_cvt_pk_bf16_f32 v115, v118, v119
    v_cvt_pk_bf16_f32 v116, v120, v121
    v_cvt_pk_bf16_f32 v117, v122, v123
    v_cvt_pk_bf16_f32 v118, v124, v125
    v_mfma_f32_32x32x16_bf16 v[144:159], a[252:255], a[140:143], v[144:159]
    s_waitcnt lgkmcnt(1)
    ds_read_b128 a[248:251], v67 offset:26624
    v_cvt_pk_bf16_f32 v119, v126, v127
    v_and_or_b32 v112, v112, v61, v62
    v_and_or_b32 v113, v113, v61, v62
    v_and_or_b32 v114, v114, v61, v62
    v_and_or_b32 v115, v115, v61, v62
    v_mfma_f32_32x32x16_bf16 v[144:159], a[240:243], a[144:147], v[144:159]
    s_waitcnt lgkmcnt(1)
    ds_read_b128 a[252:255], v67 offset:27648
    v_and_or_b32 v116, v116, v61, v62
    v_and_or_b32 v117, v117, v61, v62
    v_and_or_b32 v118, v118, v61, v62
    v_and_or_b32 v119, v119, v61, v62
    v_add_f32 v54, v54, v216
    v_mfma_f32_32x32x16_bf16 v[144:159], a[244:247], a[148:151], v[144:159]
    s_waitcnt lgkmcnt(1)
    ds_read_b128 a[240:243], v67 offset:28672
    global_load_lds_dwordx4 v7, s[52:53] offset:0 sc1
    v_add_f32 v52, v52, v201
    v_add_f32 v54, v54, v217
    v_mfma_f32_32x32x16_bf16 v[144:159], a[248:251], a[152:155], v[144:159]
    s_waitcnt lgkmcnt(1)
    ds_read_b128 a[244:247], v67 offset:29696
    buffer_store_dwordx4 v[112:115], v7, s[36:39], s46 offen offset:2048 sc1
    v_add_f32 v52, v52, v202
    v_add_f32 v54, v54, v218
    v_mfma_f32_32x32x16_bf16 v[144:159], a[252:255], a[156:159], v[144:159]
    s_waitcnt lgkmcnt(1)
    ds_read_b128 a[248:251], v67 offset:30720
    buffer_store_dwordx4 v[116:119], v7, s[36:39], s46 offen offset:3072 sc1
    v_add_f32 v52, v52, v203
    v_add_f32 v54, v54, v219
    v_mfma_f32_32x32x16_bf16 v[144:159], a[240:243], a[160:163], v[144:159]
    s_waitcnt lgkmcnt(1)
    ds_read_b128 a[252:255], v67 offset:31744
    v_add_f32 v52, v52, v204
    v_add_f32 v54, v54, v220
    v_add_f32 v52, v52, v205
    v_add_f32 v54, v54, v221
    v_add_f32 v52, v52, v206
    v_mfma_f32_32x32x16_bf16 v[144:159], a[244:247], a[164:167], v[144:159]
    s_waitcnt vmcnt(7) lgkmcnt(1)
    s_barrier
    ds_read_b128 a[240:243], v67 offset:32768
    global_load_lds_dwordx4 v7, s[52:53] offset:1024 sc1
    v_add_f32 v54, v54, v222
    v_add_f32 v52, v52, v207
    v_mfma_f32_32x32x16_bf16 v[144:159], a[248:251], a[168:171], v[144:159]
    s_waitcnt lgkmcnt(1)
    ds_read_b128 a[244:247], v67 offset:33792
    v_add_f32 v54, v54, v223
    v_mov_b32 v50, v52
    v_mov_b32 v51, v54
    v_mfma_f32_32x32x16_bf16 v[144:159], a[252:255], a[172:175], v[144:159]
    s_waitcnt lgkmcnt(1)
    ds_read_b128 a[248:251], v67 offset:34816
    v_permlane32_swap_b32 v50, v52
    v_permlane32_swap_b32 v51, v54
    v_add_f32 v52, v52, v50
    v_add_f32 v54, v54, v51
    v_mfma_f32_32x32x16_bf16 v[144:159], a[240:243], a[176:179], v[144:159]
    s_waitcnt lgkmcnt(1)
    ds_read_b128 a[252:255], v67 offset:35840
    v_rcp_f32 v52, v52
    v_rcp_f32 v54, v54
    v_mfma_f32_32x32x16_bf16 v[144:159], a[244:247], a[180:183], v[144:159]
    s_waitcnt lgkmcnt(1)
    ds_read_b128 a[240:243], v67 offset:36864
    global_load_lds_dwordx4 v7, s[52:53] offset:2048 sc1
    v_mul_f32 v192, v52, v192
    v_mul_f32 v208, v54, v208
    v_mfma_f32_32x32x16_bf16 v[144:159], a[248:251], a[184:187], v[144:159]
    s_waitcnt lgkmcnt(1)
    ds_read_b128 a[244:247], v67 offset:37888
    v_mul_f32 v193, v52, v193
    v_mul_f32 v209, v54, v209
    v_mul_f32 v194, v52, v194
    v_mul_f32 v210, v54, v210
    v_mul_f32 v195, v52, v195
    v_mfma_f32_32x32x16_bf16 v[144:159], a[252:255], a[188:191], v[144:159]
    s_waitcnt lgkmcnt(1)
    ds_read_b128 a[248:251], v67 offset:38912
    v_mul_f32 v211, v54, v211
    v_mul_f32 v196, v52, v196
    v_mul_f32 v212, v54, v212
    v_mul_f32 v197, v52, v197
    v_mul_f32 v213, v54, v213
    v_mfma_f32_32x32x16_bf16 v[144:159], a[240:243], a[192:195], v[144:159]
    s_waitcnt lgkmcnt(1)
    ds_read_b128 a[252:255], v67 offset:39936
    v_mul_f32 v198, v52, v198
    v_mul_f32 v214, v54, v214
    v_mul_f32 v199, v52, v199
    v_mul_f32 v215, v54, v215
    v_mul_f32 v200, v52, v200
    v_mfma_f32_32x32x16_bf16 v[144:159], a[244:247], a[196:199], v[144:159]
    s_waitcnt lgkmcnt(1)
    ds_read_b128 a[240:243], v67 offset:40960
    global_load_lds_dwordx4 v7, s[52:53] offset:3072 sc1
    s_add_u32 m0, m0, 16384
    s_add_u32 s52, s52, 16384
    s_addc_u32 s53, s53, 0
    v_mul_f32 v216, v54, v216
    v_mul_f32 v201, v52, v201
    v_mfma_f32_32x32x16_bf16 v[144:159], a[248:251], a[200:203], v[144:159]
    s_waitcnt lgkmcnt(1)
    ds_read_b128 a[244:247], v67 offset:41984
    v_mul_f32 v217, v54, v217
    v_mul_f32 v202, v52, v202
    v_mul_f32 v218, v54, v218
    v_mul_f32 v203, v52, v203
    v_mul_f32 v219, v54, v219
    v_mfma_f32_32x32x16_bf16 v[144:159], a[252:255], a[204:207], v[144:159]
    s_waitcnt lgkmcnt(1)
    ds_read_b128 a[248:251], v67 offset:43008
    v_mul_f32 v204, v52, v204
    v_mul_f32 v220, v54, v220
    v_mul_f32 v205, v52, v205
    v_mul_f32 v221, v54, v221
    v_mul_f32 v206, v52, v206
    v_mfma_f32_32x32x16_bf16 v[144:159], a[240:243], a[208:211], v[144:159]
    s_waitcnt lgkmcnt(1)
    ds_read_b128 a[252:255], v67 offset:44032
    v_mul_f32 v222, v54, v222
    v_mul_f32 v207, v52, v207
    v_mul_f32 v223, v54, v223
    v_cvt_pk_bf16_f32 v128, v192, v193
    v_cvt_pk_bf16_f32 v136, v208, v209
    v_mfma_f32_32x32x16_bf16 v[144:159], a[244:247], a[212:215], v[144:159]
    s_waitcnt lgkmcnt(1)
    ds_read_b128 a[240:243], v67 offset:45056
    global_load_lds_dwordx4 v7, s[52:53] offset:0 sc1
    v_cvt_pk_bf16_f32 v129, v194, v195
    v_cvt_pk_bf16_f32 v137, v210, v211
    v_mfma_f32_32x32x16_bf16 v[144:159], a[248:251], a[216:219], v[144:159]
    s_waitcnt lgkmcnt(1)
    ds_read_b128 a[244:247], v67 offset:46080
    v_cvt_pk_bf16_f32 v130, v196, v197
    v_cvt_pk_bf16_f32 v138, v212, v213
    v_cvt_pk_bf16_f32 v131, v198, v199
    v_cvt_pk_bf16_f32 v139, v214, v215
    v_cvt_pk_bf16_f32 v132, v200, v201
    v_mfma_f32_32x32x16_bf16 v[144:159], a[252:255], a[220:223], v[144:159]
    s_waitcnt lgkmcnt(1)
    ds_read_b128 a[248:251], v67 offset:47104
    v_cvt_pk_bf16_f32 v140, v216, v217
    v_cvt_pk_bf16_f32 v133, v202, v203
    v_cvt_pk_bf16_f32 v141, v218, v219
    v_cvt_pk_bf16_f32 v134, v204, v205
    v_cvt_pk_bf16_f32 v142, v220, v221
    v_mfma_f32_32x32x16_bf16 v[144:159], a[240:243], a[224:227], v[144:159]
    s_waitcnt lgkmcnt(1)
    ds_read_b128 a[252:255], v67 offset:48128
    v_cvt_pk_bf16_f32 v135, v206, v207
    v_cvt_pk_bf16_f32 v143, v222, v223
    ds_write_b64 v56, v[128:129]
    v_xor_b32 v69, 16, v56
    ds_write_b64 v69, v[130:131]
    v_mfma_f32_32x32x16_bf16 v[144:159], a[244:247], a[228:231], v[144:159]
    s_waitcnt vmcnt(7) lgkmcnt(3)
    s_barrier
    ds_read_b128 a[240:243], v67 offset:49152
    global_load_lds_dwordx4 v7, s[52:53] offset:1024 sc1
    v_xor_b32 v69, 32, v56
    ds_write_b64 v69, v[132:133]
    v_mfma_f32_32x32x16_bf16 v[144:159], a[248:251], a[232:235], v[144:159]
    s_waitcnt lgkmcnt(4)
    ds_read_b128 a[244:247], v67 offset:50176
    v_xor_b32 v69, 48, v56
    ds_write_b64 v69, v[134:135]
    v_xor_b32 v69, 64, v56
    ds_write_b64 v69, v[136:137]
    v_xor_b32 v69, 80, v56
    v_mfma_f32_32x32x16_bf16 v[144:159], a[252:255], a[236:239], v[144:159]
    s_waitcnt lgkmcnt(4)
    ds_read_b128 a[248:251], v67 offset:51200
    ds_write_b64 v69, v[138:139]
    v_xor_b32 v69, 96, v56
    ds_write_b64 v69, v[140:141]
    v_xor_b32 v69, 112, v56
    ds_write_b64 v69, v[142:143]
    v_mfma_f32_32x32x16_bf16 v[160:175], a[128:131], a[240:243], 0
    s_waitcnt lgkmcnt(6)
    ds_read_b128 a[252:255], v67 offset:52224
    v_mfma_f32_32x32x16_bf16 v[160:175], a[132:135], a[244:247], v[160:175]
    s_waitcnt lgkmcnt(4)
    ds_read_b128 a[240:243], v67 offset:53248
    global_load_lds_dwordx4 v7, s[52:53] offset:2048 sc1
    v_cvt_pk_bf16_f32 v144, v144, v145
    v_cvt_pk_bf16_f32 v145, v146, v147
    v_mfma_f32_32x32x16_bf16 v[160:175], a[136:139], a[248:251], v[160:175]
    s_waitcnt lgkmcnt(1)
    ds_read_b128 a[244:247], v67 offset:54272
    v_cvt_pk_bf16_f32 v146, v148, v149
    v_cvt_pk_bf16_f32 v147, v150, v151
    v_cvt_pk_bf16_f32 v148, v152, v153
    v_cvt_pk_bf16_f32 v149, v154, v155
    v_cvt_pk_bf16_f32 v150, v156, v157
    v_mfma_f32_32x32x16_bf16 v[160:175], a[140:143], a[252:255], v[160:175]
    s_waitcnt lgkmcnt(1)
    ds_read_b128 a[248:251], v67 offset:55296
    v_cvt_pk_bf16_f32 v151, v158, v159
    v_and_b32 v150, v150, v10
    v_and_b32 v151, v151, v10
    v_mfma_f32_32x32x16_bf16 v[160:175], a[144:147], a[240:243], v[160:175]
    s_waitcnt lgkmcnt(1)
    ds_read_b128 a[252:255], v67 offset:56320
    v_mfma_f32_32x32x16_bf16 v[76:91], a[48:51], v[144:147], 0
    v_mfma_f32_32x32x16_bf16 v[76:91], a[52:55], v[148:151], v[76:91]
    v_mfma_f32_32x32x16_bf16 v[160:175], a[148:151], a[244:247], v[160:175]
    s_waitcnt lgkmcnt(1)
    ds_read_b128 a[240:243], v67 offset:57344
    global_load_lds_dwordx4 v7, s[52:53] offset:3072 sc1
    s_lshl_b32 s3, s50, 11
    s_mov_b32 m0, s3
    s_sub_u32 s3, 16384, s3
    s_add_u32 s52, s52, s3
    s_addc_u32 s53, s53, 0
    v_mfma_f32_32x32x16_bf16 v[160:175], a[152:155], a[248:251], v[160:175]
    s_waitcnt lgkmcnt(1)
    ds_read_b128 a[244:247], v67 offset:58368
    ds_read_b64_tr_b16 v[112:113], v57 offset:0
    ds_read_b64_tr_b16 v[114:115], v58 offset:1024
    ds_read_b64_tr_b16 v[116:117], v57 offset:2048
    ds_read_b64_tr_b16 v[118:119], v58 offset:3072
    v_mfma_f32_32x32x16_bf16 v[160:175], a[156:159], a[252:255], v[160:175]
    s_waitcnt lgkmcnt(5)
    ds_read_b128 a[248:251], v67 offset:59392
    ds_read_b64_tr_b16 v[120:121], v59 offset:0
    ds_read_b64_tr_b16 v[122:123], v60 offset:1024
    ds_read_b64_tr_b16 v[124:125], v59 offset:2048
    ds_read_b64_tr_b16 v[126:127], v60 offset:3072
    v_cvt_pk_bf16_f32 v192, v76, v77
    v_mfma_f32_32x32x16_bf16 v[160:175], a[160:163], a[240:243], v[160:175]
    s_waitcnt lgkmcnt(9)
    ds_read_b128 a[252:255], v67 offset:60416
    v_cvt_pk_bf16_f32 v193, v78, v79
    v_cvt_pk_bf16_f32 v194, v80, v81
    v_cvt_pk_bf16_f32 v195, v82, v83
    v_cvt_pk_bf16_f32 v196, v84, v85
    v_cvt_pk_bf16_f32 v197, v86, v87
    v_mfma_f32_32x32x16_bf16 v[160:175], a[164:167], a[244:247], v[160:175]
    s_waitcnt lgkmcnt(5)
    ds_read_b128 a[240:243], v67 offset:61440
    global_load_lds_dwordx4 v7, s[52:53] offset:0 sc1
    v_cvt_pk_bf16_f32 v198, v88, v89
    v_cvt_pk_bf16_f32 v199, v90, v91
    v_mfma_f32_32x32x16_bf16 v[160:175], a[168:171], a[248:251], v[160:175]
    s_waitcnt lgkmcnt(1)
    ds_read_b128 a[244:247], v67 offset:62464
    v_lshlrev_b32 v76, 16, v192
    v_and_b32 v77, 0xffff0000, v192
    v_lshlrev_b32 v78, 16, v193
    v_and_b32 v79, 0xffff0000, v193
    v_lshlrev_b32 v80, 16, v194
    v_mfma_f32_32x32x16_bf16 v[160:175], a[172:175], a[252:255], v[160:175]
    s_waitcnt lgkmcnt(1)
    ds_read_b128 a[248:251], v67 offset:63488
    v_and_b32 v81, 0xffff0000, v194
    v_lshlrev_b32 v82, 16, v195
    v_and_b32 v83, 0xffff0000, v195
    v_lshlrev_b32 v84, 16, v196
    v_and_b32 v85, 0xffff0000, v196
    v_mfma_f32_32x32x16_bf16 v[160:175], a[176:179], a[240:243], v[160:175]
    s_waitcnt lgkmcnt(1)
    ds_read_b128 a[252:255], v67 offset:64512
    v_lshlrev_b32 v86, 16, v197
    v_and_b32 v87, 0xffff0000, v197
    v_lshlrev_b32 v88, 16, v198
    v_and_b32 v89, 0xffff0000, v198
    v_lshlrev_b32 v90, 16, v199
    v_mfma_f32_32x32x16_bf16 v[160:175], a[180:183], a[244:247], v[160:175]
    s_waitcnt vmcnt(5) lgkmcnt(1)
    s_barrier
    s_mov_b64 exec, 0xff
    buffer_store_dwordx4 v[252:255], v7, s[36:39], s4 offen sc1
    s_mov_b64 exec, -1
    ds_read_b128 a[240:243], v68 offset:0
    global_load_lds_dwordx4 v7, s[52:53] offset:1024 sc1
    v_mfma_f32_32x32x16_bf16 v[160:175], a[184:187], a[248:251], v[160:175]
    s_waitcnt lgkmcnt(1)
    ds_read_b128 a[244:247], v68 offset:1024
    v_and_b32 v91, 0xffff0000, v199
    v_max3_f32 v48, v76, v77, v78
    v_min3_f32 v49, v76, v77, v78
    v_max3_f32 v48, v48, v79, v80
    v_min3_f32 v49, v49, v79, v80
    v_mfma_f32_32x32x16_bf16 v[160:175], a[188:191], a[252:255], v[160:175]
    s_waitcnt lgkmcnt(1)
    ds_read_b128 a[248:251], v68 offset:2048
    v_max3_f32 v48, v48, v81, v82
    v_min3_f32 v49, v49, v81, v82
    v_max3_f32 v48, v48, v83, v84
    v_min3_f32 v49, v49, v83, v84
    v_max3_f32 v48, v48, v85, v86
    v_mfma_f32_32x32x16_bf16 v[160:175], a[192:195], a[240:243], v[160:175]
    s_waitcnt lgkmcnt(1)
    ds_read_b128 a[252:255], v68 offset:3072
    v_min3_f32 v49, v49, v85, v86
    v_max3_f32 v48, v48, v87, v88
    v_min3_f32 v49, v49, v87, v88
    v_max3_f32 v48, v48, v89, v90
    v_min3_f32 v49, v49, v89, v90
    v_mfma_f32_32x32x16_bf16 v[160:175], a[196:199], a[244:247], v[160:175]
    s_waitcnt lgkmcnt(1)
    ds_read_b128 a[240:243], v68 offset:4096
    v_max_f32 v48, v48, v91
    v_min_f32 v49, v49, v91
    v_mov_b32 v50, v48
    v_mov_b32 v51, v49
    v_mfma_f32_32x32x16_bf16 v[160:175], a[200:203], a[248:251], v[160:175]
    s_waitcnt lgkmcnt(1)
    ds_read_b128 a[244:247], v68 offset:5120
    v_permlane32_swap_b32 v50, v48
    v_permlane32_swap_b32 v51, v49
    v_max_f32 v48, v48, v50
    v_min_f32 v49, v49, v51
    v_mul_f32 v48, s27, v48
    v_mfma_f32_32x32x16_bf16 v[160:175], a[204:207], a[252:255], v[160:175]
    s_waitcnt lgkmcnt(1)
    ds_read_b128 a[248:251], v68 offset:6144
    v_mul_f32 v49, s27, v49
    v_fma_f32 v192, v76, s27, -v48
    v_fma_f32 v208, -v76, s27, v49
    v_fma_f32 v193, v77, s27, -v48
    v_fma_f32 v209, -v77, s27, v49
    v_mfma_f32_32x32x16_bf16 v[160:175], a[208:211], a[240:243], v[160:175]
    s_waitcnt lgkmcnt(1)
    ds_read_b128 a[252:255], v68 offset:7168
    s_lshl_b32 s3, s61, 2
    s_add_u32 s3, s3, s50
    s_mul_i32 s3, s3, 3200
    v_lshlrev_b32 v70, 7, v1
    v_add_u32 v70, s3, v70
    v_min_u32 v70, 401280, v70
    s_mov_b64 exec, 0x1ffffff
    global_load_dword v250, v70, s[10:11]
    global_load_dword v250, v70, s[16:17]
    s_mov_b64 exec, -1
    v_mfma_f32_32x32x16_bf16 v[160:175], a[212:215], a[244:247], v[160:175]
    s_waitcnt lgkmcnt(1)
    ds_read_b128 a[240:243], v68 offset:8192
    v_fma_f32 v194, v78, s27, -v48
    v_fma_f32 v210, -v78, s27, v49
    v_fma_f32 v195, v79, s27, -v48
    v_fma_f32 v211, -v79, s27, v49
    v_fma_f32 v196, v80, s27, -v48
    v_mfma_f32_32x32x16_bf16 v[160:175], a[216:219], a[248:251], v[160:175]
    s_waitcnt lgkmcnt(1)
    ds_read_b128 a[244:247], v68 offset:9216
    v_fma_f32 v212, -v80, s27, v49
    v_fma_f32 v197, v81, s27, -v48
    v_fma_f32 v213, -v81, s27, v49
    v_fma_f32 v198, v82, s27, -v48
    v_fma_f32 v214, -v82, s27, v49
    v_mfma_f32_32x32x16_bf16 v[160:175], a[220:223], a[252:255], v[160:175]
    s_waitcnt lgkmcnt(1)
    ds_read_b128 a[248:251], v68 offset:10240
    v_fma_f32 v199, v83, s27, -v48
    v_fma_f32 v215, -v83, s27, v49
    v_fma_f32 v200, v84, s27, -v48
    v_fma_f32 v216, -v84, s27, v49
    v_fma_f32 v201, v85, s27, -v48
    v_mfma_f32_32x32x16_bf16 v[160:175], a[224:227], a[240:243], v[160:175]
    s_waitcnt lgkmcnt(1)
    ds_read_b128 a[252:255], v68 offset:11264
    v_fma_f32 v217, -v85, s27, v49
    v_fma_f32 v202, v86, s27, -v48
    v_fma_f32 v218, -v86, s27, v49
    v_fma_f32 v203, v87, s27, -v48
    v_fma_f32 v219, -v87, s27, v49
    v_mfma_f32_32x32x16_bf16 v[160:175], a[228:231], a[244:247], v[160:175]
    s_waitcnt lgkmcnt(1)
    ds_read_b128 a[240:243], v68 offset:12288
    v_fma_f32 v204, v88, s27, -v48
    v_fma_f32 v220, -v88, s27, v49
    v_fma_f32 v205, v89, s27, -v48
    v_fma_f32 v221, -v89, s27, v49
    v_fma_f32 v206, v90, s27, -v48
    v_mfma_f32_32x32x16_bf16 v[160:175], a[232:235], a[248:251], v[160:175]
    s_waitcnt lgkmcnt(1)
    ds_read_b128 a[244:247], v68 offset:13312
    v_fma_f32 v222, -v90, s27, v49
    v_fma_f32 v207, v91, s27, -v48
    v_fma_f32 v223, -v91, s27, v49
    v_exp_f32 v192, v192
    v_mfma_f32_32x32x16_bf16 v[160:175], a[236:239], a[252:255], v[160:175]
    s_waitcnt lgkmcnt(1)
    ds_read_b128 a[248:251], v68 offset:14336
    v_exp_f32 v208, v208
    v_exp_f32 v193, v193
    v_mfma_f32_32x32x16_bf16 v[176:191], a[240:243], a[128:131], 0
    s_waitcnt lgkmcnt(1)
    ds_read_b128 a[252:255], v68 offset:15360
    v_exp_f32 v209, v209
    v_exp_f32 v194, v194
    v_mfma_f32_32x32x16_bf16 v[176:191], a[244:247], a[132:135], v[176:191]
    s_waitcnt vmcnt(5) lgkmcnt(1)
    s_barrier
    ds_read_b128 a[240:243], v68 offset:16384
    v_cvt_pk_bf16_f32 v160, v160, v161
    v_cvt_pk_bf16_f32 v161, v162, v163
    v_cvt_pk_bf16_f32 v162, v164, v165
    v_cvt_pk_bf16_f32 v163, v166, v167
    v_cvt_pk_bf16_f32 v164, v168, v169
    v_mfma_f32_32x32x16_bf16 v[176:191], a[248:251], a[136:139], v[176:191]
    s_waitcnt lgkmcnt(1)
    ds_read_b128 a[244:247], v68 offset:17408
    v_cvt_pk_bf16_f32 v165, v170, v171
    v_cvt_pk_bf16_f32 v166, v172, v173
    v_cvt_pk_bf16_f32 v167, v174, v175
    v_and_or_b32 v160, v160, v61, v62
    v_and_or_b32 v161, v161, v61, v62
    v_mfma_f32_32x32x16_bf16 v[176:191], a[252:255], a[140:143], v[176:191]
    s_waitcnt lgkmcnt(1)
    ds_read_b128 a[248:251], v68 offset:18432
    v_and_or_b32 v162, v162, v61, v62
    v_and_or_b32 v163, v163, v61, v62
    v_and_or_b32 v164, v164, v61, v62
    v_and_or_b32 v165, v165, v61, v62
    v_and_or_b32 v166, v166, v61, v62
    v_mfma_f32_32x32x16_bf16 v[176:191], a[240:243], a[144:147], v[176:191]
    s_waitcnt lgkmcnt(1)
    ds_read_b128 a[252:255], v68 offset:19456
    v_and_or_b32 v167, v167, v61, v62
    v_exp_f32 v210, v210
    v_mfma_f32_32x32x16_bf16 v[176:191], a[244:247], a[148:151], v[176:191]
    s_waitcnt lgkmcnt(1)
    ds_read_b128 a[240:243], v68 offset:20480
    v_mfma_f32_32x32x16_bf16 v[128:143], v[112:115], v[160:163], 0
    v_mfma_f32_32x32x16_bf16 v[128:143], v[116:119], v[164:167], v[128:143]
    v_mfma_f32_32x32x16_bf16 v[144:159], v[120:123], v[160:163], 0
    v_mfma_f32_32x32x16_bf16 v[144:159], v[124:127], v[164:167], v[144:159]
    v_exp_f32 v195, v195
    v_exp_f32 v211, v211
    v_exp_f32 v196, v196
    v_mfma_f32_32x32x16_bf16 v[176:191], a[248:251], a[152:155], v[176:191]
    s_waitcnt lgkmcnt(1)
    ds_read_b128 a[244:247], v68 offset:21504
    buffer_load_dwordx2 v[248:249], v16, s[36:39], s47 offen sc1
    v_exp_f32 v212, v212
    v_mfma_f32_32x32x16_bf16 v[176:191], a[252:255], a[156:159], v[176:191]
    s_waitcnt lgkmcnt(1)
    ds_read_b128 a[248:251], v68 offset:22528
    v_exp_f32 v197, v197
    v_exp_f32 v213, v213
    v_mfma_f32_32x32x16_bf16 v[176:191], a[240:243], a[160:163], v[176:191]
    s_waitcnt lgkmcnt(1)
    ds_read_b128 a[252:255], v68 offset:23552
    v_exp_f32 v198, v198
    v_exp_f32 v214, v214
    v_mfma_f32_32x32x16_bf16 v[176:191], a[244:247], a[164:167], v[176:191]
    s_waitcnt lgkmcnt(1)
    ds_read_b128 a[240:243], v68 offset:24576
    v_exp_f32 v199, v199
    v_exp_f32 v215, v215
    v_mfma_f32_32x32x16_bf16 v[176:191], a[248:251], a[168:171], v[176:191]
    s_waitcnt lgkmcnt(1)
    ds_read_b128 a[244:247], v68 offset:25600
    v_exp_f32 v200, v200
    v_exp_f32 v216, v216
    v_mfma_f32_32x32x16_bf16 v[176:191], a[252:255], a[172:175], v[176:191]
    s_waitcnt lgkmcnt(1)
    ds_read_b128 a[248:251], v68 offset:26624
    v_exp_f32 v201, v201
    v_exp_f32 v217, v217
    v_mfma_f32_32x32x16_bf16 v[176:191], a[240:243], a[176:179], v[176:191]
    s_waitcnt lgkmcnt(1)
    ds_read_b128 a[252:255], v68 offset:27648
    v_exp_f32 v202, v202
    v_exp_f32 v218, v218
    v_mfma_f32_32x32x16_bf16 v[176:191], a[244:247], a[180:183], v[176:191]
    s_waitcnt lgkmcnt(1)
    ds_read_b128 a[240:243], v68 offset:28672
    v_exp_f32 v203, v203
    v_exp_f32 v219, v219
    v_mfma_f32_32x32x16_bf16 v[176:191], a[248:251], a[184:187], v[176:191]
    s_waitcnt lgkmcnt(1)
    ds_read_b128 a[244:247], v68 offset:29696
    v_exp_f32 v204, v204
    v_exp_f32 v220, v220
    v_mfma_f32_32x32x16_bf16 v[176:191], a[252:255], a[188:191], v[176:191]
    s_waitcnt lgkmcnt(1)
    ds_read_b128 a[248:251], v68 offset:30720
    v_exp_f32 v205, v205
    v_exp_f32 v221, v221
    v_mfma_f32_32x32x16_bf16 v[176:191], a[240:243], a[192:195], v[176:191]
    s_waitcnt lgkmcnt(1)
    ds_read_b128 a[252:255], v68 offset:31744
    v_exp_f32 v206, v206
    v_exp_f32 v222, v222
    v_mfma_f32_32x32x16_bf16 v[176:191], a[244:247], a[196:199], v[176:191]
    s_waitcnt vmcnt(3) lgkmcnt(0)
    s_barrier
    ds_read_b128 a[240:243], v7 offset:0
    v_exp_f32 v207, v207
    v_exp_f32 v223, v223
    v_add_f32 v52, v192, v193
    v_mfma_f32_32x32x16_bf16 v[176:191], a[248:251], a[200:203], v[176:191]
    ds_read_b128 a[244:247], v7 offset:1024
    v_add_f32 v54, v208, v209
    v_mul_f32 v204, v65, v204
    v_mul_f32 v220, v65, v220
    v_mul_f32 v205, v65, v205
    v_mul_f32 v221, v65, v221
    v_mfma_f32_32x32x16_bf16 v[176:191], a[252:255], a[204:207], v[176:191]
    s_waitcnt lgkmcnt(1)
    ds_read_b128 a[248:251], v7 offset:2048
    v_mul_f32 v206, v65, v206
    v_mul_f32 v222, v65, v222
    v_mul_f32 v207, v65, v207
    v_mul_f32 v223, v65, v223
    v_add_f32 v52, v52, v194
    v_mfma_f32_32x32x16_bf16 v[176:191], a[240:243], a[208:211], v[176:191]
    s_waitcnt lgkmcnt(1)
    ds_read_b128 a[252:255], v7 offset:3072
    s_waitcnt vmcnt(0)
    v_cmp_ne_u64 vcc, s[64:65], v[248:249]
    v_add_f32 v54, v54, v210
    v_add_f32 v52, v52, v195
    v_add_f32 v54, v54, v211
    v_mfma_f32_32x32x16_bf16 v[176:191], a[244:247], a[212:215], v[176:191]
    s_waitcnt lgkmcnt(1)
    ds_read_b128 a[240:243], v7 offset:4096
    v_add_f32 v52, v52, v196
    v_add_f32 v54, v54, v212
    v_add_f32 v52, v52, v197
    v_add_f32 v54, v54, v213
    v_add_f32 v52, v52, v198
    v_mfma_f32_32x32x16_bf16 v[176:191], a[248:251], a[216:219], v[176:191]
    s_waitcnt lgkmcnt(1)
    ds_read_b128 a[244:247], v7 offset:5120
    s_cbranch_vccnz L_pb_s
L_pb_ok:
    ds_write_b128 v21, v[128:131] offset:0
    ds_write_b128 v21, v[132:135] offset:1024
    ds_write_b128 v21, v[136:139] offset:2048
    v_mfma_f32_32x32x16_bf16 v[176:191], a[252:255], a[220:223], v[176:191]
    s_waitcnt lgkmcnt(4)
    ds_read_b128 a[248:251], v7 offset:6144
    global_load_dwordx4 a[64:67], v7, s[0:1] offset:0 sc1
    global_load_dwordx4 a[68:71], v7, s[0:1] offset:1024 sc1
    global_load_dwordx4 a[72:75], v7, s[0:1] offset:2048 sc1
    global_load_dwordx4 a[76:79], v7, s[0:1] offset:3072 sc1
    s_add_u32 s0, s0, 4352
    s_addc_u32 s1, s1, 0
    v_mfma_f32_32x32x16_bf16 v[176:191], a[240:243], a[224:227], v[176:191]
    s_waitcnt lgkmcnt(4)
    ds_read_b128 a[252:255], v7 offset:7168
    ds_write_b128 v21, v[140:143] offset:3072
    ds_write_b128 v21, v[144:147] offset:4096
    ds_write_b128 v21, v[148:151] offset:5120
    ds_write_b128 v21, v[152:155] offset:6144
    ds_write_b128 v21, v[156:159] offset:7168
    v_mfma_f32_32x32x16_bf16 v[176:191], a[244:247], a[228:231], v[176:191]
    s_waitcnt lgkmcnt(6)
    v_add_f32 v54, v54, v214
    v_add_f32 v52, v52, v199
    v_add_f32 v54, v54, v215
    v_add_f32 v52, v52, v200
    v_add_f32 v54, v54, v216
    v_mfma_f32_32x32x16_bf16 v[176:191], a[248:251], a[232:235], v[176:191]
    s_waitcnt lgkmcnt(5)
    v_add_f32 v52, v52, v201
    v_add_f32 v54, v54, v217
    v_add_f32 v52, v52, v202
    v_add_f32 v54, v54, v218
    v_add_f32 v52, v52, v203
    v_mfma_f32_32x32x16_bf16 v[176:191], a[252:255], a[236:239], v[176:191]
    global_load_dwordx4 a[80:83], v7, s[0:1] offset:0 sc1
    global_load_dwordx4 a[84:87], v7, s[0:1] offset:1024 sc1
    global_load_dwordx4 a[88:91], v7, s[0:1] offset:2048 sc1
    global_load_dwordx4 a[92:95], v7, s[0:1] offset:3072 sc1
    s_add_u32 s0, s0, 4352
    s_addc_u32 s1, s1, 0
    v_add_f32 v54, v54, v219
    v_add_f32 v52, v52, v204
    v_add_f32 v54, v54, v220
    v_add_f32 v52, v52, v205
    v_add_f32 v54, v54, v221
    v_add_f32 v52, v52, v206
    v_add_f32 v54, v54, v222
    v_add_f32 v52, v52, v207
    v_add_f32 v54, v54, v223
    v_mov_b32 v50, v52
    v_mov_b32 v51, v54
    s_nop 1
    v_permlane32_swap_b32 v50, v52
    v_permlane32_swap_b32 v51, v54
    v_add_f32 v52, v52, v50
    v_add_f32 v54, v54, v51
    v_rcp_f32 v52, v52
    v_rcp_f32 v54, v54
    s_nop 0
    v_mov_b32 v11, v188
    v_mov_b32 v3, v188
    v_pk_mul_f32 v[176:177], v[176:177], s[44:45] op_sel:[0,1] op_sel_hi:[1,1]
    v_pk_mul_f32 v[178:179], v[178:179], s[44:45] op_sel:[0,1] op_sel_hi:[1,1]
    v_pk_mul_f32 v[180:181], v[180:181], s[44:45] op_sel:[0,1] op_sel_hi:[1,1]
    v_pk_mul_f32 v[182:183], v[182:183], s[44:45] op_sel:[0,1] op_sel_hi:[1,1]
    v_pk_mul_f32 v[184:185], v[184:185], s[44:45] op_sel:[0,1] op_sel_hi:[1,1]
    v_pk_mul_f32 v[186:187], v[186:187], s[44:45] op_sel:[0,1] op_sel_hi:[1,1]
    v_pk_mul_f32 v[188:189], v[188:189], s[44:45] op_sel:[0,1] op_sel_hi:[1,1]
    v_pk_mul_f32 v[190:191], v[190:191], s[44:45] op_sel:[0,1] op_sel_hi:[1,1]
    v_permlane32_swap_b32 v3, v11
    v_cvt_pk_bf16_f32 v176, v176, v177
    v_cvt_pk_bf16_f32 v177, v178, v179
    v_cvt_pk_bf16_f32 v178, v180, v181
    v_cvt_pk_bf16_f32 v179, v182, v183
    v_cvt_pk_bf16_f32 v180, v184, v185
    v_cvt_pk_bf16_f32 v181, v186, v187
    v_cvt_pk_bf16_f32 v182, v188, v189
    v_cvt_pk_bf16_f32 v183, v190, v191
    v_and_b32 v182, v182, v10
    v_and_b32 v183, v183, v10
    v_mfma_f32_32x32x16_bf16 v[76:91], v[96:99], v[176:179], 0
    ds_write_b128 v19, v[176:179]
    v_cvt_pk_bf16_f32 v11, v11, v11
    v_lshlrev_b32 v11, 16, v11
    v_mul_f32 v11, 0xbfb8aa3b, v11
    v_exp_f32 v11, v11
    v_mfma_f32_32x32x16_bf16 v[76:91], v[100:103], v[180:183], v[76:91]
    global_load_dwordx4 a[96:99], v7, s[0:1] offset:0 sc1
    global_load_dwordx4 a[100:103], v7, s[0:1] offset:1024 sc1
    global_load_dwordx4 a[104:107], v7, s[0:1] offset:2048 sc1
    global_load_dwordx4 a[108:111], v7, s[0:1] offset:3072 sc1
    s_add_u32 s0, s0, 4352
    s_addc_u32 s1, s1, 0
    v_add_f32 v11, 1.0, v11
    v_rcp_f32 v11, v11
    v_pk_mul_f32 v[192:193], v[192:193], v[52:53] op_sel_hi:[1,0]
    v_pk_mul_f32 v[208:209], v[208:209], v[54:55] op_sel_hi:[1,0]
    v_pk_mul_f32 v[194:195], v[194:195], v[52:53] op_sel_hi:[1,0]
    v_pk_mul_f32 v[210:211], v[210:211], v[54:55] op_sel_hi:[1,0]
    v_max3_f32 v3, v76, v77, v78
    v_max3_f32 v3, v3, v79, v80
    v_max3_f32 v3, v3, v81, v82
    v_max3_f32 v3, v3, v83, v84
    v_max3_f32 v3, v3, v85, v86
    v_max3_f32 v3, v3, v87, v88
    v_max3_f32 v3, v3, v89, v90
    v_max_f32 v3, v3, v91
    v_mov_b32 v4, v3
    v_pk_mul_f32 v[196:197], v[196:197], v[52:53] op_sel_hi:[1,0]
    v_pk_mul_f32 v[212:213], v[212:213], v[54:55] op_sel_hi:[1,0]
    v_permlane32_swap_b32 v4, v3
    v_max_f32 v3, v3, v4
    s_mov_b64 exec, s[62:63]
    v_xor_b32 v3, 0x80000000, v3
    v_and_b32 v4, 0xffff0000, v3
    v_sub_f32 v3, v3, v4
    v_and_b32 v5, 0xffff0000, v3
    v_sub_f32 v3, v3, v5
    v_lshrrev_b32 v4, 16, v4
    v_or_b32 v182, v4, v5
    v_lshrrev_b32 v183, 16, v3
    s_mov_b64 exec, -1
    ds_write_b128 v19, v[180:183] offset:1024
    v_xor_b32 v3, 2048, v19
    v_xor_b32 v4, 4096, v19
    v_xor_b32 v5, 6144, v19
    v_pk_mul_f32 v[198:199], v[198:199], v[52:53] op_sel_hi:[1,0]
    v_pk_mul_f32 v[214:215], v[214:215], v[54:55] op_sel_hi:[1,0]
    v_pk_mul_f32 v[200:201], v[200:201], v[52:53] op_sel_hi:[1,0]
    v_pk_mul_f32 v[216:217], v[216:217], v[54:55] op_sel_hi:[1,0]
    v_pk_mul_f32 v[202:203], v[202:203], v[52:53] op_sel_hi:[1,0]
    v_pk_mul_f32 v[218:219], v[218:219], v[54:55] op_sel_hi:[1,0]
    v_pk_mul_f32 v[204:205], v[204:205], v[52:53] op_sel_hi:[1,0]
    v_pk_mul_f32 v[220:221], v[220:221], v[54:55] op_sel_hi:[1,0]
    v_pk_mul_f32 v[206:207], v[206:207], v[52:53] op_sel_hi:[1,0]
    v_pk_mul_f32 v[222:223], v[222:223], v[54:55] op_sel_hi:[1,0]
    v_cvt_pk_bf16_f32 v11, v11, v11
    v_lshlrev_b32 v11, 16, v11
    s_waitcnt lgkmcnt(0)
    s_barrier
    ds_read_b128 a[128:131], v3 offset:0
    ds_read_b128 a[132:135], v3 offset:1024
    ds_read_b128 a[136:139], v4 offset:0
    ds_read_b128 a[140:143], v4 offset:1024
    ds_read_b128 v[128:131], v22 offset:0
    ds_read_b128 v[132:135], v22 offset:1024
    ds_read_b128 v[136:139], v22 offset:8192
    ds_read_b128 v[140:143], v22 offset:9216
    ds_read_b128 a[144:147], v5 offset:0
    ds_read_b128 a[148:151], v5 offset:1024
    ds_read_b128 a[152:155], v19 offset:0
    ds_read_b128 a[156:159], v19 offset:1024
    global_load_dwordx4 a[112:115], v7, s[0:1] offset:0 sc1
    global_load_dwordx4 a[116:119], v7, s[0:1] offset:1024 sc1
    global_load_dwordx4 a[120:123], v7, s[0:1] offset:2048 sc1
    global_load_dwordx4 a[124:127], v7, s[0:1] offset:3072 sc1
    s_add_u32 s0, s0, 4352
    s_addc_u32 s1, s1, 0
    v_cvt_pk_bf16_f32 v224, v192, v193
    v_cvt_pk_bf16_f32 v232, v208, v209
    v_cvt_pk_bf16_f32 v225, v194, v195
    v_cvt_pk_bf16_f32 v233, v210, v211
    v_cvt_pk_bf16_f32 v226, v196, v197
    v_cvt_pk_bf16_f32 v234, v212, v213
    v_cvt_pk_bf16_f32 v227, v198, v199
    v_cvt_pk_bf16_f32 v235, v214, v215
    v_cvt_pk_bf16_f32 v228, v200, v201
    v_cvt_pk_bf16_f32 v236, v216, v217
    s_waitcnt vmcnt(12) lgkmcnt(10)
    v_mfma_f32_32x32x16_bf16 v[48:63], a[64:67], a[128:131], 0
    ds_read_b128 v[144:147], v22 offset:16384
    ds_read_b128 v[148:151], v22 offset:17408
    ds_read_b128 v[152:155], v22 offset:24576
    ds_read_b128 v[156:159], v22 offset:25600
    v_cvt_pk_bf16_f32 v229, v202, v203
    v_cvt_pk_bf16_f32 v237, v218, v219
    v_mfma_f32_32x32x16_bf16 v[48:63], a[68:71], a[132:135], v[48:63]
    v_cvt_pk_bf16_f32 v230, v204, v205
    v_cvt_pk_bf16_f32 v238, v220, v221
    v_cvt_pk_bf16_f32 v231, v206, v207
    v_cvt_pk_bf16_f32 v239, v222, v223
    s_waitcnt lgkmcnt(8)
    v_mfma_f32_32x32x16_bf16 v[64:79], a[64:67], a[136:139], 0
    v_add_f32 v128, v128, v136
    v_add_f32 v129, v129, v137
    v_add_f32 v130, v130, v138
    v_add_f32 v131, v131, v139
    v_add_f32 v132, v132, v140
    v_add_f32 v133, v133, v141
    v_mfma_f32_32x32x16_bf16 v[64:79], a[68:71], a[140:143], v[64:79]
    s_waitcnt lgkmcnt(0)
    v_add_f32 v134, v134, v142
    v_add_f32 v135, v135, v143
    v_add_f32 v144, v144, v152
    v_add_f32 v145, v145, v153
    v_add_f32 v146, v146, v154
    v_add_f32 v147, v147, v155
    v_add_f32 v148, v148, v156
    v_add_f32 v149, v149, v157
    v_add_f32 v150, v150, v158
    v_add_f32 v151, v151, v159
    v_add_f32 v192, v128, v144
    v_add_f32 v193, v129, v145
    v_add_f32 v194, v130, v146
    v_add_f32 v195, v131, v147
    v_add_f32 v196, v132, v148
    v_add_f32 v197, v133, v149
    v_add_f32 v198, v134, v150
    v_add_f32 v199, v135, v151
    v_mfma_f32_32x32x16_bf16 v[80:95], a[64:67], a[144:147], 0
    buffer_atomic_add_f32 v192, v9, s[36:39], s60 offen offset:0 sc1
    buffer_atomic_add_f32 v193, v9, s[36:39], s60 offen offset:256 sc1
    buffer_atomic_add_f32 v194, v9, s[36:39], s60 offen offset:512 sc1
    buffer_atomic_add_f32 v195, v9, s[36:39], s60 offen offset:768 sc1
    v_exp_f32 v48, v48
    v_exp_f32 v49, v49
    v_exp_f32 v50, v50
    v_exp_f32 v51, v51
    v_exp_f32 v52, v52
    v_exp_f32 v53, v53
    v_exp_f32 v54, v54
    v_exp_f32 v55, v55
    v_mfma_f32_32x32x16_bf16 v[80:95], a[68:71], a[148:151], v[80:95]
    buffer_atomic_add_f32 v196, v9, s[36:39], s60 offen offset:1024 sc1
    buffer_atomic_add_f32 v197, v9, s[36:39], s60 offen offset:1280 sc1
    buffer_atomic_add_f32 v198, v9, s[36:39], s60 offen offset:1536 sc1
    buffer_atomic_add_f32 v199, v9, s[36:39], s60 offen offset:1792 sc1
    v_exp_f32 v56, v56
    v_exp_f32 v57, v57
    v_exp_f32 v58, v58
    v_exp_f32 v59, v59
    v_smfmac_f32_32x32x32_bf16 a[0:15], a[72:75], v[48:55], v8
    v_exp_f32 v60, v60
    v_exp_f32 v61, v61
    v_exp_f32 v62, v62
    v_exp_f32 v63, v63
    v_mfma_f32_32x32x16_bf16 v[96:111], a[64:67], a[152:155], 0
    v_exp_f32 v64, v64
    v_exp_f32 v65, v65
    v_exp_f32 v66, v66
    v_exp_f32 v67, v67
    v_smfmac_f32_32x32x32_bf16 a[0:15], a[76:79], v[56:63], v8
    v_exp_f32 v68, v68
    v_exp_f32 v69, v69
    v_exp_f32 v70, v70
    v_exp_f32 v71, v71
    v_mfma_f32_32x32x16_bf16 v[96:111], a[68:71], a[156:159], v[96:111]
    v_exp_f32 v72, v72
    v_exp_f32 v73, v73
    v_exp_f32 v74, v74
    v_exp_f32 v75, v75
    v_smfmac_f32_32x32x32_bf16 a[16:31], a[72:75], v[64:71], v8
    s_waitcnt vmcnt(16)
    v_exp_f32 v76, v76
    v_exp_f32 v77, v77
    v_exp_f32 v78, v78
    v_exp_f32 v79, v79
    v_mfma_f32_32x32x16_bf16 v[48:63], a[80:83], a[128:131], 0
    v_exp_f32 v80, v80
    v_exp_f32 v81, v81
    v_exp_f32 v82, v82
    v_exp_f32 v83, v83
    v_smfmac_f32_32x32x32_bf16 a[16:31], a[76:79], v[72:79], v8
    v_exp_f32 v84, v84
    v_exp_f32 v85, v85
    v_exp_f32 v86, v86
    v_exp_f32 v87, v87
    v_mfma_f32_32x32x16_bf16 v[48:63], a[84:87], a[132:135], v[48:63]
    v_exp_f32 v88, v88
    v_exp_f32 v89, v89
    v_exp_f32 v90, v90
    v_exp_f32 v91, v91
    v_smfmac_f32_32x32x32_bf16 a[32:47], a[72:75], v[80:87], v8
    v_exp_f32 v92, v92
    v_exp_f32 v93, v93
    v_exp_f32 v94, v94
    v_exp_f32 v95, v95
    v_mfma_f32_32x32x16_bf16 v[64:79], a[80:83], a[136:139], 0
    s_add_u32 m0, s15, 0
    v_exp_f32 v96, v96
    v_exp_f32 v97, v97
    v_exp_f32 v98, v98
    v_exp_f32 v99, v99
    v_smfmac_f32_32x32x32_bf16 a[32:47], a[76:79], v[88:95], v8
    global_load_lds_dwordx4 v12, s[28:29] offset:0
    global_load_lds_dwordx4 v13, s[28:29] offset:1024
    v_exp_f32 v100, v100
    v_exp_f32 v101, v101
    v_exp_f32 v102, v102
    v_exp_f32 v103, v103
    v_mfma_f32_32x32x16_bf16 v[64:79], a[84:87], a[140:143], v[64:79]
    v_exp_f32 v104, v104
    v_exp_f32 v105, v105
    v_exp_f32 v106, v106
    v_exp_f32 v107, v107
    v_smfmac_f32_32x32x32_bf16 v[32:47], a[72:75], v[96:103], v8
    v_exp_f32 v108, v108
    v_exp_f32 v109, v109
    v_exp_f32 v110, v110
    v_exp_f32 v111, v111
    v_mfma_f32_32x32x16_bf16 v[80:95], a[80:83], a[144:147], 0
    v_exp_f32 v48, v48
    v_exp_f32 v49, v49
    v_exp_f32 v50, v50
    v_exp_f32 v51, v51
    v_smfmac_f32_32x32x32_bf16 v[32:47], a[76:79], v[104:111], v8
    v_exp_f32 v52, v52
    v_exp_f32 v53, v53
    v_exp_f32 v54, v54
    v_exp_f32 v55, v55
    v_mfma_f32_32x32x16_bf16 v[80:95], a[84:87], a[148:151], v[80:95]
    v_exp_f32 v56, v56
    v_exp_f32 v57, v57
    v_exp_f32 v58, v58
    v_exp_f32 v59, v59
    v_smfmac_f32_32x32x32_bf16 a[0:15], a[88:91], v[48:55], v8
    v_exp_f32 v60, v60
    v_exp_f32 v61, v61
    v_exp_f32 v62, v62
    v_exp_f32 v63, v63
    v_mfma_f32_32x32x16_bf16 v[96:111], a[80:83], a[152:155], 0
    v_exp_f32 v64, v64
    v_exp_f32 v65, v65
    v_exp_f32 v66, v66
    v_exp_f32 v67, v67
    v_smfmac_f32_32x32x32_bf16 a[0:15], a[92:95], v[56:63], v8
    global_load_dwordx4 a[64:67], v7, s[0:1] offset:0 sc1
    global_load_dwordx4 a[68:71], v7, s[0:1] offset:1024 sc1
    global_load_dwordx4 a[72:75], v7, s[0:1] offset:2048 sc1
    global_load_dwordx4 a[76:79], v7, s[0:1] offset:3072 sc1
    s_add_u32 s0, s0, 4352
    s_addc_u32 s1, s1, 0
    v_exp_f32 v68, v68
    v_exp_f32 v69, v69
    v_exp_f32 v70, v70
    v_exp_f32 v71, v71
    v_mfma_f32_32x32x16_bf16 v[96:111], a[84:87], a[156:159], v[96:111]
    v_exp_f32 v72, v72
    v_exp_f32 v73, v73
    v_exp_f32 v74, v74
    v_exp_f32 v75, v75
    v_smfmac_f32_32x32x32_bf16 a[16:31], a[88:91], v[64:71], v8
    s_waitcnt vmcnt(18)
    v_exp_f32 v76, v76
    v_exp_f32 v77, v77
    v_exp_f32 v78, v78
    v_exp_f32 v79, v79
    v_mfma_f32_32x32x16_bf16 v[48:63], a[96:99], a[128:131], 0
    v_exp_f32 v80, v80
    v_exp_f32 v81, v81
    v_exp_f32 v82, v82
    v_exp_f32 v83, v83
    v_smfmac_f32_32x32x32_bf16 a[16:31], a[92:95], v[72:79], v8
    v_exp_f32 v84, v84
    v_exp_f32 v85, v85
    v_exp_f32 v86, v86
    v_exp_f32 v87, v87
    v_mfma_f32_32x32x16_bf16 v[48:63], a[100:103], a[132:135], v[48:63]
    v_exp_f32 v88, v88
    v_exp_f32 v89, v89
    v_exp_f32 v90, v90
    v_exp_f32 v91, v91
    v_smfmac_f32_32x32x32_bf16 a[32:47], a[88:91], v[80:87], v8
    v_exp_f32 v92, v92
    v_exp_f32 v93, v93
    v_exp_f32 v94, v94
    v_exp_f32 v95, v95
    v_mfma_f32_32x32x16_bf16 v[64:79], a[96:99], a[136:139], 0
    v_exp_f32 v96, v96
    v_exp_f32 v97, v97
    v_exp_f32 v98, v98
    v_exp_f32 v99, v99
    v_smfmac_f32_32x32x32_bf16 a[32:47], a[92:95], v[88:95], v8
    global_load_lds_dwordx4 v14, s[28:29] offset:2048
    global_load_lds_dwordx4 v15, s[28:29] offset:3072
    v_exp_f32 v100, v100
    v_exp_f32 v101, v101
    v_exp_f32 v102, v102
    v_exp_f32 v103, v103
    v_mfma_f32_32x32x16_bf16 v[64:79], a[100:103], a[140:143], v[64:79]
    s_add_u32 s28, s28, 28672
    s_addc_u32 s29, s29, 0
    v_exp_f32 v104, v104
    v_exp_f32 v105, v105
    v_exp_f32 v106, v106
    v_exp_f32 v107, v107
    v_smfmac_f32_32x32x32_bf16 v[32:47], a[88:91], v[96:103], v8
    v_exp_f32 v108, v108
    v_exp_f32 v109, v109
    v_exp_f32 v110, v110
    v_exp_f32 v111, v111
    v_mfma_f32_32x32x16_bf16 v[80:95], a[96:99], a[144:147], 0
    v_exp_f32 v48, v48
    v_exp_f32 v49, v49
    v_exp_f32 v50, v50
    v_exp_f32 v51, v51
    v_smfmac_f32_32x32x32_bf16 v[32:47], a[92:95], v[104:111], v8
    v_exp_f32 v52, v52
    v_exp_f32 v53, v53
    v_exp_f32 v54, v54
    v_exp_f32 v55, v55
    v_mfma_f32_32x32x16_bf16 v[80:95], a[100:103], a[148:151], v[80:95]
    v_exp_f32 v56, v56
    v_exp_f32 v57, v57
    v_exp_f32 v58, v58
    v_exp_f32 v59, v59
    v_smfmac_f32_32x32x32_bf16 a[0:15], a[104:107], v[48:55], v8
    v_exp_f32 v60, v60
    v_exp_f32 v61, v61
    v_exp_f32 v62, v62
    v_exp_f32 v63, v63
    v_mfma_f32_32x32x16_bf16 v[96:111], a[96:99], a[152:155], 0
    v_exp_f32 v64, v64
    v_exp_f32 v65, v65
    v_exp_f32 v66, v66
    v_exp_f32 v67, v67
    v_smfmac_f32_32x32x32_bf16 a[0:15], a[108:111], v[56:63], v8
    global_load_dwordx4 a[80:83], v7, s[0:1] offset:0 sc1
    global_load_dwordx4 a[84:87], v7, s[0:1] offset:1024 sc1
    global_load_dwordx4 a[88:91], v7, s[0:1] offset:2048 sc1
    global_load_dwordx4 a[92:95], v7, s[0:1] offset:3072 sc1
    s_add_u32 s0, s0, 4352
    s_addc_u32 s1, s1, 0
    v_exp_f32 v68, v68
    v_exp_f32 v69, v69
    v_exp_f32 v70, v70
    v_exp_f32 v71, v71
    v_mfma_f32_32x32x16_bf16 v[96:111], a[100:103], a[156:159], v[96:111]
    v_exp_f32 v72, v72
    v_exp_f32 v73, v73
    v_exp_f32 v74, v74
    v_exp_f32 v75, v75
    v_smfmac_f32_32x32x32_bf16 a[16:31], a[104:107], v[64:71], v8
    s_waitcnt vmcnt(20)
    v_exp_f32 v76, v76
    v_exp_f32 v77, v77
    v_exp_f32 v78, v78
    v_exp_f32 v79, v79
    v_mfma_f32_32x32x16_bf16 v[48:63], a[112:115], a[128:131], 0
    v_exp_f32 v80, v80
    v_exp_f32 v81, v81
    v_exp_f32 v82, v82
    v_exp_f32 v83, v83
    v_smfmac_f32_32x32x32_bf16 a[16:31], a[108:111], v[72:79], v8
    v_exp_f32 v84, v84
    v_exp_f32 v85, v85
    v_exp_f32 v86, v86
    v_exp_f32 v87, v87
    v_mfma_f32_32x32x16_bf16 v[48:63], a[116:119], a[132:135], v[48:63]
    v_exp_f32 v88, v88
    v_exp_f32 v89, v89
    v_exp_f32 v90, v90
    v_exp_f32 v91, v91
    v_smfmac_f32_32x32x32_bf16 a[32:47], a[104:107], v[80:87], v8
    v_exp_f32 v92, v92
    v_exp_f32 v93, v93
    v_exp_f32 v94, v94
    v_exp_f32 v95, v95
    v_mfma_f32_32x32x16_bf16 v[64:79], a[112:115], a[136:139], 0
    s_add_u32 m0, s15, 14336
    v_exp_f32 v96, v96
    v_exp_f32 v97, v97
    v_exp_f32 v98, v98
    v_exp_f32 v99, v99
    v_smfmac_f32_32x32x32_bf16 a[32:47], a[108:111], v[88:95], v8
    global_load_lds_dwordx4 v12, s[30:31] offset:0
    global_load_lds_dwordx4 v13, s[30:31] offset:1024
    v_exp_f32 v100, v100
    v_exp_f32 v101, v101
    v_exp_f32 v102, v102
    v_exp_f32 v103, v103
    v_mfma_f32_32x32x16_bf16 v[64:79], a[116:119], a[140:143], v[64:79]
    v_exp_f32 v104, v104
    v_exp_f32 v105, v105
    v_exp_f32 v106, v106
    v_exp_f32 v107, v107
    v_smfmac_f32_32x32x32_bf16 v[32:47], a[104:107], v[96:103], v8
    v_exp_f32 v108, v108
    v_exp_f32 v109, v109
    v_exp_f32 v110, v110
    v_exp_f32 v111, v111
    v_mfma_f32_32x32x16_bf16 v[80:95], a[112:115], a[144:147], 0
    v_exp_f32 v48, v48
    v_exp_f32 v49, v49
    v_exp_f32 v50, v50
    v_exp_f32 v51, v51
    v_smfmac_f32_32x32x32_bf16 v[32:47], a[108:111], v[104:111], v8
    v_exp_f32 v52, v52
    v_exp_f32 v53, v53
    v_exp_f32 v54, v54
    v_exp_f32 v55, v55
    v_mfma_f32_32x32x16_bf16 v[80:95], a[116:119], a[148:151], v[80:95]
    v_exp_f32 v56, v56
    v_exp_f32 v57, v57
    v_exp_f32 v58, v58
    v_exp_f32 v59, v59
    v_smfmac_f32_32x32x32_bf16 a[0:15], a[120:123], v[48:55], v8
    v_exp_f32 v60, v60
    v_exp_f32 v61, v61
    v_exp_f32 v62, v62
    v_exp_f32 v63, v63
    v_mfma_f32_32x32x16_bf16 v[96:111], a[112:115], a[152:155], 0
    v_exp_f32 v64, v64
    v_exp_f32 v65, v65
    v_exp_f32 v66, v66
    v_exp_f32 v67, v67
    v_smfmac_f32_32x32x32_bf16 a[0:15], a[124:127], v[56:63], v8
    global_load_dwordx4 a[96:99], v7, s[0:1] offset:0 sc1
    global_load_dwordx4 a[100:103], v7, s[0:1] offset:1024 sc1
    global_load_dwordx4 a[104:107], v7, s[0:1] offset:2048 sc1
    global_load_dwordx4 a[108:111], v7, s[0:1] offset:3072 sc1
    s_add_u32 s0, s0, 4352
    s_addc_u32 s1, s1, 0
    v_exp_f32 v68, v68
    v_exp_f32 v69, v69
    v_exp_f32 v70, v70
    v_exp_f32 v71, v71
    v_mfma_f32_32x32x16_bf16 v[96:111], a[116:119], a[156:159], v[96:111]
    v_exp_f32 v72, v72
    v_exp_f32 v73, v73
    v_exp_f32 v74, v74
    v_exp_f32 v75, v75
    v_smfmac_f32_32x32x32_bf16 a[16:31], a[120:123], v[64:71], v8
    s_waitcnt vmcnt(12)
    v_exp_f32 v76, v76
    v_exp_f32 v77, v77
    v_exp_f32 v78, v78
    v_exp_f32 v79, v79
    v_mfma_f32_32x32x16_bf16 v[48:63], a[64:67], a[128:131], 0
    v_exp_f32 v80, v80
    v_exp_f32 v81, v81
    v_exp_f32 v82, v82
    v_exp_f32 v83, v83
    v_smfmac_f32_32x32x32_bf16 a[16:31], a[124:127], v[72:79], v8
    v_exp_f32 v84, v84
    v_exp_f32 v85, v85
    v_exp_f32 v86, v86
    v_exp_f32 v87, v87
    v_mfma_f32_32x32x16_bf16 v[48:63], a[68:71], a[132:135], v[48:63]
    v_exp_f32 v88, v88
    v_exp_f32 v89, v89
    v_exp_f32 v90, v90
    v_exp_f32 v91, v91
    v_smfmac_f32_32x32x32_bf16 a[32:47], a[120:123], v[80:87], v8
    v_exp_f32 v92, v92
    v_exp_f32 v93, v93
    v_exp_f32 v94, v94
    v_exp_f32 v95, v95
    v_mfma_f32_32x32x16_bf16 v[64:79], a[64:67], a[136:139], 0
    v_exp_f32 v96, v96
    v_exp_f32 v97, v97
    v_exp_f32 v98, v98
    v_exp_f32 v99, v99
    v_smfmac_f32_32x32x32_bf16 a[32:47], a[124:127], v[88:95], v8
    global_load_lds_dwordx4 v14, s[30:31] offset:2048
    global_load_lds_dwordx4 v15, s[30:31] offset:3072
    v_exp_f32 v100, v100
    v_exp_f32 v101, v101
    v_exp_f32 v102, v102
    v_exp_f32 v103, v103
    v_mfma_f32_32x32x16_bf16 v[64:79], a[68:71], a[140:143], v[64:79]
    s_add_u32 s30, s30, 28672
    s_addc_u32 s31, s31, 0
    s_lshl_b32 s55, s48, 9
    v_exp_f32 v104, v104
    v_exp_f32 v105, v105
    v_exp_f32 v106, v106
    v_exp_f32 v107, v107
    v_smfmac_f32_32x32x32_bf16 v[32:47], a[120:123], v[96:103], v8
    s_add_u32 s15, s15, 4096
    s_mov_b64 exec, 0xff
    buffer_store_dwordx4 v[252:255], v7, s[36:39], s5 offen sc1
    s_mov_b64 exec, -1
    v_exp_f32 v108, v108
    v_exp_f32 v109, v109
    v_exp_f32 v110, v110
    v_exp_f32 v111, v111
    v_mfma_f32_32x32x16_bf16 v[80:95], a[64:67], a[144:147], 0
    s_add_u32 s55, s55, 7602176
    v_exp_f32 v48, v48
    v_exp_f32 v49, v49
    v_exp_f32 v50, v50
    v_exp_f32 v51, v51
    v_smfmac_f32_32x32x32_bf16 v[32:47], a[124:127], v[104:111], v8
    v_exp_f32 v52, v52
    v_exp_f32 v53, v53
    v_exp_f32 v54, v54
    v_exp_f32 v55, v55
    v_mfma_f32_32x32x16_bf16 v[80:95], a[68:71], a[148:151], v[80:95]
    v_exp_f32 v56, v56
    v_exp_f32 v57, v57
    v_exp_f32 v58, v58
    v_exp_f32 v59, v59
    v_smfmac_f32_32x32x32_bf16 a[0:15], a[72:75], v[48:55], v8
    v_exp_f32 v60, v60
    v_exp_f32 v61, v61
    v_exp_f32 v62, v62
    v_exp_f32 v63, v63
    v_mfma_f32_32x32x16_bf16 v[96:111], a[64:67], a[152:155], 0
    v_exp_f32 v64, v64
    v_exp_f32 v65, v65
    v_exp_f32 v66, v66
    v_exp_f32 v67, v67
    v_smfmac_f32_32x32x32_bf16 a[0:15], a[76:79], v[56:63], v8
    global_load_dwordx4 a[112:115], v7, s[0:1] offset:0 sc1
    global_load_dwordx4 a[116:119], v7, s[0:1] offset:1024 sc1
    global_load_dwordx4 a[120:123], v7, s[0:1] offset:2048 sc1
    global_load_dwordx4 a[124:127], v7, s[0:1] offset:3072 sc1
    s_add_u32 s0, s0, 4352
    s_addc_u32 s1, s1, 0
    v_exp_f32 v68, v68
    v_exp_f32 v69, v69
    v_exp_f32 v70, v70
    v_exp_f32 v71, v71
    v_mfma_f32_32x32x16_bf16 v[96:111], a[68:71], a[156:159], v[96:111]
    v_exp_f32 v72, v72
    v_exp_f32 v73, v73
    v_exp_f32 v74, v74
    v_exp_f32 v75, v75
    v_smfmac_f32_32x32x32_bf16 a[16:31], a[72:75], v[64:71], v8
    s_waitcnt vmcnt(13)
    v_exp_f32 v76, v76
    v_exp_f32 v77, v77
    v_exp_f32 v78, v78
    v_exp_f32 v79, v79
    v_mfma_f32_32x32x16_bf16 v[48:63], a[80:83], a[128:131], 0
    v_exp_f32 v80, v80
    v_exp_f32 v81, v81
    v_exp_f32 v82, v82
    v_exp_f32 v83, v83
    v_smfmac_f32_32x32x32_bf16 a[16:31], a[76:79], v[72:79], v8
    v_exp_f32 v84, v84
    v_exp_f32 v85, v85
    v_exp_f32 v86, v86
    v_exp_f32 v87, v87
    v_mfma_f32_32x32x16_bf16 v[48:63], a[84:87], a[132:135], v[48:63]
    v_exp_f32 v88, v88
    v_exp_f32 v89, v89
    v_exp_f32 v90, v90
    v_exp_f32 v91, v91
    v_smfmac_f32_32x32x32_bf16 a[32:47], a[72:75], v[80:87], v8
    v_exp_f32 v92, v92
    v_exp_f32 v93, v93
    v_exp_f32 v94, v94
    v_exp_f32 v95, v95
    v_mfma_f32_32x32x16_bf16 v[64:79], a[80:83], a[136:139], 0
    s_add_u32 m0, s15, 0
    v_exp_f32 v96, v96
    v_exp_f32 v97, v97
    v_exp_f32 v98, v98
    v_exp_f32 v99, v99
    v_smfmac_f32_32x32x32_bf16 a[32:47], a[76:79], v[88:95], v8
    global_load_lds_dwordx4 v12, s[28:29] offset:0
    global_load_lds_dwordx4 v13, s[28:29] offset:1024
    v_exp_f32 v100, v100
    v_exp_f32 v101, v101
    v_exp_f32 v102, v102
    v_exp_f32 v103, v103
    v_mfma_f32_32x32x16_bf16 v[64:79], a[84:87], a[140:143], v[64:79]
    v_exp_f32 v104, v104
    v_exp_f32 v105, v105
    v_exp_f32 v106, v106
    v_exp_f32 v107, v107
    v_smfmac_f32_32x32x32_bf16 v[32:47], a[72:75], v[96:103], v8
    v_exp_f32 v108, v108
    v_exp_f32 v109, v109
    v_exp_f32 v110, v110
    v_exp_f32 v111, v111
    v_mfma_f32_32x32x16_bf16 v[80:95], a[80:83], a[144:147], 0
    v_exp_f32 v48, v48
    v_exp_f32 v49, v49
    v_exp_f32 v50, v50
    v_exp_f32 v51, v51
    v_smfmac_f32_32x32x32_bf16 v[32:47], a[76:79], v[104:111], v8
    v_exp_f32 v52, v52
    v_exp_f32 v53, v53
    v_exp_f32 v54, v54
    v_exp_f32 v55, v55
    v_mfma_f32_32x32x16_bf16 v[80:95], a[84:87], a[148:151], v[80:95]
    v_exp_f32 v56, v56
    v_exp_f32 v57, v57
    v_exp_f32 v58, v58
    v_exp_f32 v59, v59
    v_smfmac_f32_32x32x32_bf16 a[0:15], a[88:91], v[48:55], v8
    v_exp_f32 v60, v60
    v_exp_f32 v61, v61
    v_exp_f32 v62, v62
    v_exp_f32 v63, v63
    v_mfma_f32_32x32x16_bf16 v[96:111], a[80:83], a[152:155], 0
    v_exp_f32 v64, v64
    v_exp_f32 v65, v65
    v_exp_f32 v66, v66
    v_exp_f32 v67, v67
    v_smfmac_f32_32x32x32_bf16 a[0:15], a[92:95], v[56:63], v8
    global_load_dwordx4 a[64:67], v7, s[0:1] offset:0 sc1
    global_load_dwordx4 a[68:71], v7, s[0:1] offset:1024 sc1
    global_load_dwordx4 a[72:75], v7, s[0:1] offset:2048 sc1
    global_load_dwordx4 a[76:79], v7, s[0:1] offset:3072 sc1
    s_add_u32 s0, s0, 4352
    s_addc_u32 s1, s1, 0
    v_exp_f32 v68, v68
    v_exp_f32 v69, v69
    v_exp_f32 v70, v70
    v_exp_f32 v71, v71
    v_mfma_f32_32x32x16_bf16 v[96:111], a[84:87], a[156:159], v[96:111]
    v_exp_f32 v72, v72
    v_exp_f32 v73, v73
    v_exp_f32 v74, v74
    v_exp_f32 v75, v75
    v_smfmac_f32_32x32x32_bf16 a[16:31], a[88:91], v[64:71], v8
    s_waitcnt vmcnt(13)
    v_exp_f32 v76, v76
    v_exp_f32 v77, v77
    v_exp_f32 v78, v78
    v_exp_f32 v79, v79
    v_mfma_f32_32x32x16_bf16 v[48:63], a[96:99], a[128:131], 0
    v_exp_f32 v80, v80
    v_exp_f32 v81, v81
    v_exp_f32 v82, v82
    v_exp_f32 v83, v83
    v_smfmac_f32_32x32x32_bf16 a[16:31], a[92:95], v[72:79], v8
    v_exp_f32 v84, v84
    v_exp_f32 v85, v85
    v_exp_f32 v86, v86
    v_exp_f32 v87, v87
    v_mfma_f32_32x32x16_bf16 v[48:63], a[100:103], a[132:135], v[48:63]
    v_exp_f32 v88, v88
    v_exp_f32 v89, v89
    v_exp_f32 v90, v90
    v_exp_f32 v91, v91
    v_smfmac_f32_32x32x32_bf16 a[32:47], a[88:91], v[80:87], v8
    v_exp_f32 v92, v92
    v_exp_f32 v93, v93
    v_exp_f32 v94, v94
    v_exp_f32 v95, v95
    v_mfma_f32_32x32x16_bf16 v[64:79], a[96:99], a[136:139], 0
    v_exp_f32 v96, v96
    v_exp_f32 v97, v97
    v_exp_f32 v98, v98
    v_exp_f32 v99, v99
    v_smfmac_f32_32x32x32_bf16 a[32:47], a[92:95], v[88:95], v8
    global_load_lds_dwordx4 v14, s[28:29] offset:2048
    global_load_lds_dwordx4 v15, s[28:29] offset:3072
    v_exp_f32 v100, v100
    v_exp_f32 v101, v101
    v_exp_f32 v102, v102
    v_exp_f32 v103, v103
    v_mfma_f32_32x32x16_bf16 v[64:79], a[100:103], a[140:143], v[64:79]
    s_add_u32 s28, s28, 28672
    s_addc_u32 s29, s29, 0
    v_exp_f32 v104, v104
    v_exp_f32 v105, v105
    v_exp_f32 v106, v106
    v_exp_f32 v107, v107
    v_smfmac_f32_32x32x32_bf16 v[32:47], a[88:91], v[96:103], v8
    v_exp_f32 v108, v108
    v_exp_f32 v109, v109
    v_exp_f32 v110, v110
    v_exp_f32 v111, v111
    v_mfma_f32_32x32x16_bf16 v[80:95], a[96:99], a[144:147], 0
    v_exp_f32 v48, v48
    v_exp_f32 v49, v49
    v_exp_f32 v50, v50
    v_exp_f32 v51, v51
    v_smfmac_f32_32x32x32_bf16 v[32:47], a[92:95], v[104:111], v8
    v_exp_f32 v52, v52
    v_exp_f32 v53, v53
    v_exp_f32 v54, v54
    v_exp_f32 v55, v55
    v_mfma_f32_32x32x16_bf16 v[80:95], a[100:103], a[148:151], v[80:95]
    v_exp_f32 v56, v56
    v_exp_f32 v57, v57
    v_exp_f32 v58, v58
    v_exp_f32 v59, v59
    v_smfmac_f32_32x32x32_bf16 a[0:15], a[104:107], v[48:55], v8
    v_exp_f32 v60, v60
    v_exp_f32 v61, v61
    v_exp_f32 v62, v62
    v_exp_f32 v63, v63
    v_mfma_f32_32x32x16_bf16 v[96:111], a[96:99], a[152:155], 0
    v_exp_f32 v64, v64
    v_exp_f32 v65, v65
    v_exp_f32 v66, v66
    v_exp_f32 v67, v67
    v_smfmac_f32_32x32x32_bf16 a[0:15], a[108:111], v[56:63], v8
    global_load_dwordx4 a[80:83], v7, s[0:1] offset:0 sc1
    global_load_dwordx4 a[84:87], v7, s[0:1] offset:1024 sc1
    global_load_dwordx4 a[88:91], v7, s[0:1] offset:2048 sc1
    global_load_dwordx4 a[92:95], v7, s[0:1] offset:3072 sc1
    s_add_u32 s0, s0, 4352
    s_addc_u32 s1, s1, 0
    v_exp_f32 v68, v68
    v_exp_f32 v69, v69
    v_exp_f32 v70, v70
    v_exp_f32 v71, v71
    v_mfma_f32_32x32x16_bf16 v[96:111], a[100:103], a[156:159], v[96:111]
    v_exp_f32 v72, v72
    v_exp_f32 v73, v73
    v_exp_f32 v74, v74
    v_exp_f32 v75, v75
    v_smfmac_f32_32x32x32_bf16 a[16:31], a[104:107], v[64:71], v8
    s_waitcnt vmcnt(12)
    v_exp_f32 v76, v76
    v_exp_f32 v77, v77
    v_exp_f32 v78, v78
    v_exp_f32 v79, v79
    v_mfma_f32_32x32x16_bf16 v[48:63], a[112:115], a[128:131], 0
    v_exp_f32 v80, v80
    v_exp_f32 v81, v81
    v_exp_f32 v82, v82
    v_exp_f32 v83, v83
    v_smfmac_f32_32x32x32_bf16 a[16:31], a[108:111], v[72:79], v8
    v_exp_f32 v84, v84
    v_exp_f32 v85, v85
    v_exp_f32 v86, v86
    v_exp_f32 v87, v87
    v_mfma_f32_32x32x16_bf16 v[48:63], a[116:119], a[132:135], v[48:63]
    v_exp_f32 v88, v88
    v_exp_f32 v89, v89
    v_exp_f32 v90, v90
    v_exp_f32 v91, v91
    v_smfmac_f32_32x32x32_bf16 a[32:47], a[104:107], v[80:87], v8
    v_exp_f32 v92, v92
    v_exp_f32 v93, v93
    v_exp_f32 v94, v94
    v_exp_f32 v95, v95
    v_mfma_f32_32x32x16_bf16 v[64:79], a[112:115], a[136:139], 0
    s_add_u32 m0, s15, 14336
    v_exp_f32 v96, v96
    v_exp_f32 v97, v97
    v_exp_f32 v98, v98
    v_exp_f32 v99, v99
    v_smfmac_f32_32x32x32_bf16 a[32:47], a[108:111], v[88:95], v8
    global_load_lds_dwordx4 v12, s[30:31] offset:0
    global_load_lds_dwordx4 v13, s[30:31] offset:1024
    v_exp_f32 v100, v100
    v_exp_f32 v101, v101
    v_exp_f32 v102, v102
    v_exp_f32 v103, v103
    v_mfma_f32_32x32x16_bf16 v[64:79], a[116:119], a[140:143], v[64:79]
    v_exp_f32 v104, v104
    v_exp_f32 v105, v105
    v_exp_f32 v106, v106
    v_exp_f32 v107, v107
    v_smfmac_f32_32x32x32_bf16 v[32:47], a[104:107], v[96:103], v8
    v_exp_f32 v108, v108
    v_exp_f32 v109, v109
    v_exp_f32 v110, v110
    v_exp_f32 v111, v111
    v_mfma_f32_32x32x16_bf16 v[80:95], a[112:115], a[144:147], 0
    v_exp_f32 v48, v48
    v_exp_f32 v49, v49
    v_exp_f32 v50, v50
    v_exp_f32 v51, v51
    v_smfmac_f32_32x32x32_bf16 v[32:47], a[108:111], v[104:111], v8
    v_exp_f32 v52, v52
    v_exp_f32 v53, v53
    v_exp_f32 v54, v54
    v_exp_f32 v55, v55
    v_mfma_f32_32x32x16_bf16 v[80:95], a[116:119], a[148:151], v[80:95]
    buffer_load_dwordx2 v[248:249], v17, s[36:39], s55 offen sc1
    v_exp_f32 v56, v56
    v_exp_f32 v57, v57
    v_exp_f32 v58, v58
    v_exp_f32 v59, v59
    v_smfmac_f32_32x32x32_bf16 a[0:15], a[120:123], v[48:55], v8
    v_exp_f32 v60, v60
    v_exp_f32 v61, v61
    v_exp_f32 v62, v62
    v_exp_f32 v63, v63
    v_mfma_f32_32x32x16_bf16 v[96:111], a[112:115], a[152:155], 0
    v_exp_f32 v64, v64
    v_exp_f32 v65, v65
    v_exp_f32 v66, v66
    v_exp_f32 v67, v67
    v_smfmac_f32_32x32x32_bf16 a[0:15], a[124:127], v[56:63], v8
    global_load_dwordx4 a[96:99], v7, s[0:1] offset:0 sc1
    global_load_dwordx4 a[100:103], v7, s[0:1] offset:1024 sc1
    global_load_dwordx4 a[104:107], v7, s[0:1] offset:2048 sc1
    global_load_dwordx4 a[108:111], v7, s[0:1] offset:3072 sc1
    s_add_u32 s0, s0, 4352
    s_addc_u32 s1, s1, 0
    v_exp_f32 v68, v68
    v_exp_f32 v69, v69
    v_exp_f32 v70, v70
    v_exp_f32 v71, v71
    v_mfma_f32_32x32x16_bf16 v[96:111], a[116:119], a[156:159], v[96:111]
    v_exp_f32 v72, v72
    v_exp_f32 v73, v73
    v_exp_f32 v74, v74
    v_exp_f32 v75, v75
    v_smfmac_f32_32x32x32_bf16 a[16:31], a[120:123], v[64:71], v8
    s_waitcnt vmcnt(13)
    v_exp_f32 v76, v76
    v_exp_f32 v77, v77
    v_exp_f32 v78, v78
    v_exp_f32 v79, v79
    v_mfma_f32_32x32x16_bf16 v[48:63], a[64:67], a[128:131], 0
    v_exp_f32 v80, v80
    v_exp_f32 v81, v81
    v_exp_f32 v82, v82
    v_exp_f32 v83, v83
    v_smfmac_f32_32x32x32_bf16 a[16:31], a[124:127], v[72:79], v8
    v_exp_f32 v84, v84
    v_exp_f32 v85, v85
    v_exp_f32 v86, v86
    v_exp_f32 v87, v87
    v_mfma_f32_32x32x16_bf16 v[48:63], a[68:71], a[132:135], v[48:63]
    v_exp_f32 v88, v88
    v_exp_f32 v89, v89
    v_exp_f32 v90, v90
    v_exp_f32 v91, v91
    v_smfmac_f32_32x32x32_bf16 a[32:47], a[120:123], v[80:87], v8
    v_exp_f32 v92, v92
    v_exp_f32 v93, v93
    v_exp_f32 v94, v94
    v_exp_f32 v95, v95
    v_mfma_f32_32x32x16_bf16 v[64:79], a[64:67], a[136:139], 0
    v_exp_f32 v96, v96
    v_exp_f32 v97, v97
    v_exp_f32 v98, v98
    v_exp_f32 v99, v99
    v_smfmac_f32_32x32x32_bf16 a[32:47], a[124:127], v[88:95], v8
    global_load_lds_dwordx4 v14, s[30:31] offset:2048
    global_load_lds_dwordx4 v15, s[30:31] offset:3072
    v_exp_f32 v100, v100
    v_exp_f32 v101, v101
    v_exp_f32 v102, v102
    v_exp_f32 v103, v103
    v_mfma_f32_32x32x16_bf16 v[64:79], a[68:71], a[140:143], v[64:79]
    s_add_u32 s30, s30, 28672
    s_addc_u32 s31, s31, 0
    v_exp_f32 v104, v104
    v_exp_f32 v105, v105
    v_exp_f32 v106, v106
    v_exp_f32 v107, v107
    v_smfmac_f32_32x32x32_bf16 v[32:47], a[120:123], v[96:103], v8
    s_add_u32 s15, s15, 4096
    v_exp_f32 v108, v108
    v_exp_f32 v109, v109
    v_exp_f32 v110, v110
    v_exp_f32 v111, v111
    v_mfma_f32_32x32x16_bf16 v[80:95], a[64:67], a[144:147], 0
    v_exp_f32 v48, v48
    v_exp_f32 v49, v49
    v_exp_f32 v50, v50
    v_exp_f32 v51, v51
    v_smfmac_f32_32x32x32_bf16 v[32:47], a[124:127], v[104:111], v8
    v_exp_f32 v52, v52
    v_exp_f32 v53, v53
    v_exp_f32 v54, v54
    v_exp_f32 v55, v55
    v_mfma_f32_32x32x16_bf16 v[80:95], a[68:71], a[148:151], v[80:95]
    v_exp_f32 v56, v56
    v_exp_f32 v57, v57
    v_exp_f32 v58, v58
    v_exp_f32 v59, v59
    v_smfmac_f32_32x32x32_bf16 a[0:15], a[72:75], v[48:55], v8
    v_exp_f32 v60, v60
    v_exp_f32 v61, v61
    v_exp_f32 v62, v62
    v_exp_f32 v63, v63
    v_mfma_f32_32x32x16_bf16 v[96:111], a[64:67], a[152:155], 0
    v_exp_f32 v64, v64
    v_exp_f32 v65, v65
    v_exp_f32 v66, v66
    v_exp_f32 v67, v67
    v_smfmac_f32_32x32x32_bf16 a[0:15], a[76:79], v[56:63], v8
    global_load_dwordx4 a[112:115], v7, s[0:1] offset:0 sc1
    global_load_dwordx4 a[116:119], v7, s[0:1] offset:1024 sc1
    global_load_dwordx4 a[120:123], v7, s[0:1] offset:2048 sc1
    global_load_dwordx4 a[124:127], v7, s[0:1] offset:3072 sc1
    s_add_u32 s0, s0, 4352
    s_addc_u32 s1, s1, 0
    v_exp_f32 v68, v68
    v_exp_f32 v69, v69
    v_exp_f32 v70, v70
    v_exp_f32 v71, v71
    v_mfma_f32_32x32x16_bf16 v[96:111], a[68:71], a[156:159], v[96:111]
    v_exp_f32 v72, v72
    v_exp_f32 v73, v73
    v_exp_f32 v74, v74
    v_exp_f32 v75, v75
    v_smfmac_f32_32x32x32_bf16 a[16:31], a[72:75], v[64:71], v8
    s_waitcnt vmcnt(13)
    v_exp_f32 v76, v76
    v_exp_f32 v77, v77
    v_exp_f32 v78, v78
    v_exp_f32 v79, v79
    v_mfma_f32_32x32x16_bf16 v[48:63], a[80:83], a[128:131], 0
    v_exp_f32 v80, v80
    v_exp_f32 v81, v81
    v_exp_f32 v82, v82
    v_exp_f32 v83, v83
    v_smfmac_f32_32x32x32_bf16 a[16:31], a[76:79], v[72:79], v8
    v_exp_f32 v84, v84
    v_exp_f32 v85, v85
    v_exp_f32 v86, v86
    v_exp_f32 v87, v87
    v_mfma_f32_32x32x16_bf16 v[48:63], a[84:87], a[132:135], v[48:63]
    v_exp_f32 v88, v88
    v_exp_f32 v89, v89
    v_exp_f32 v90, v90
    v_exp_f32 v91, v91
    v_smfmac_f32_32x32x32_bf16 a[32:47], a[72:75], v[80:87], v8
    v_exp_f32 v92, v92
    v_exp_f32 v93, v93
    v_exp_f32 v94, v94
    v_exp_f32 v95, v95
    v_mfma_f32_32x32x16_bf16 v[64:79], a[80:83], a[136:139], 0
    s_add_u32 m0, s15, 0
    s_waitcnt vmcnt(10)
    v_cmp_ne_u64 vcc, s[64:65], v[248:249]
    v_exp_f32 v96, v96
    v_exp_f32 v97, v97
    v_exp_f32 v98, v98
    v_exp_f32 v99, v99
    v_smfmac_f32_32x32x32_bf16 a[32:47], a[76:79], v[88:95], v8
    global_load_lds_dwordx4 v12, s[28:29] offset:0
    global_load_lds_dwordx4 v13, s[28:29] offset:1024
    v_exp_f32 v100, v100
    v_exp_f32 v101, v101
    v_exp_f32 v102, v102
    v_exp_f32 v103, v103
    v_mfma_f32_32x32x16_bf16 v[64:79], a[84:87], a[140:143], v[64:79]
    s_cbranch_vccnz L_pk_s
L_pk_ok:
    v_exp_f32 v104, v104
    v_exp_f32 v105, v105
    v_exp_f32 v106, v106
    v_exp_f32 v107, v107
    v_smfmac_f32_32x32x32_bf16 v[32:47], a[72:75], v[96:103], v8
    buffer_load_dword v128, v9, s[36:39], s60 offen offset:0 sc1
    buffer_load_dword v129, v9, s[36:39], s60 offen offset:256 sc1
    buffer_load_dword v130, v9, s[36:39], s60 offen offset:512 sc1
    buffer_load_dword v131, v9, s[36:39], s60 offen offset:768 sc1
    v_exp_f32 v108, v108
    v_exp_f32 v109, v109
    v_exp_f32 v110, v110
    v_exp_f32 v111, v111
    v_mfma_f32_32x32x16_bf16 v[80:95], a[80:83], a[144:147], 0
    buffer_load_dword v132, v9, s[36:39], s60 offen offset:1024 sc1
    buffer_load_dword v133, v9, s[36:39], s60 offen offset:1280 sc1
    buffer_load_dword v134, v9, s[36:39], s60 offen offset:1536 sc1
    buffer_load_dword v135, v9, s[36:39], s60 offen offset:1792 sc1
    v_exp_f32 v48, v48
    v_exp_f32 v49, v49
    v_exp_f32 v50, v50
    v_exp_f32 v51, v51
    v_smfmac_f32_32x32x32_bf16 v[32:47], a[76:79], v[104:111], v8
    v_exp_f32 v52, v52
    v_exp_f32 v53, v53
    v_exp_f32 v54, v54
    v_exp_f32 v55, v55
    v_mfma_f32_32x32x16_bf16 v[80:95], a[84:87], a[148:151], v[80:95]
    v_exp_f32 v56, v56
    v_exp_f32 v57, v57
    v_exp_f32 v58, v58
    v_exp_f32 v59, v59
    v_smfmac_f32_32x32x32_bf16 a[0:15], a[88:91], v[48:55], v8
    v_exp_f32 v60, v60
    v_exp_f32 v61, v61
    v_exp_f32 v62, v62
    v_exp_f32 v63, v63
    v_mfma_f32_32x32x16_bf16 v[96:111], a[80:83], a[152:155], 0
    v_exp_f32 v64, v64
    v_exp_f32 v65, v65
    v_exp_f32 v66, v66
    v_exp_f32 v67, v67
    v_smfmac_f32_32x32x32_bf16 a[0:15], a[92:95], v[56:63], v8
    global_load_dwordx4 a[64:67], v7, s[0:1] offset:0 sc1
    global_load_dwordx4 a[68:71], v7, s[0:1] offset:1024 sc1
    global_load_dwordx4 a[72:75], v7, s[0:1] offset:2048 sc1
    global_load_dwordx4 a[76:79], v7, s[0:1] offset:3072 sc1
    s_add_u32 s0, s0, 4352
    s_addc_u32 s1, s1, 0
    v_exp_f32 v68, v68
    v_exp_f32 v69, v69
    v_exp_f32 v70, v70
    v_exp_f32 v71, v71
    v_mfma_f32_32x32x16_bf16 v[96:111], a[84:87], a[156:159], v[96:111]
    v_exp_f32 v72, v72
    v_exp_f32 v73, v73
    v_exp_f32 v74, v74
    v_exp_f32 v75, v75
    v_smfmac_f32_32x32x32_bf16 a[16:31], a[88:91], v[64:71], v8
    s_waitcnt vmcnt(20)
    v_exp_f32 v76, v76
    v_exp_f32 v77, v77
    v_exp_f32 v78, v78
    v_exp_f32 v79, v79
    v_mfma_f32_32x32x16_bf16 v[48:63], a[96:99], a[128:131], 0
    v_exp_f32 v80, v80
    v_exp_f32 v81, v81
    v_exp_f32 v82, v82
    v_exp_f32 v83, v83
    v_smfmac_f32_32x32x32_bf16 a[16:31], a[92:95], v[72:79], v8
    v_exp_f32 v84, v84
    v_exp_f32 v85, v85
    v_exp_f32 v86, v86
    v_exp_f32 v87, v87
    v_mfma_f32_32x32x16_bf16 v[48:63], a[100:103], a[132:135], v[48:63]
    v_exp_f32 v88, v88
    v_exp_f32 v89, v89
    v_exp_f32 v90, v90
    v_exp_f32 v91, v91
    v_smfmac_f32_32x32x32_bf16 a[32:47], a[88:91], v[80:87], v8
    v_exp_f32 v92, v92
    v_exp_f32 v93, v93
    v_exp_f32 v94, v94
    v_exp_f32 v95, v95
    v_mfma_f32_32x32x16_bf16 v[64:79], a[96:99], a[136:139], 0
    v_exp_f32 v96, v96
    v_exp_f32 v97, v97
    v_exp_f32 v98, v98
    v_exp_f32 v99, v99
    v_smfmac_f32_32x32x32_bf16 a[32:47], a[92:95], v[88:95], v8
    global_load_lds_dwordx4 v14, s[28:29] offset:2048
    global_load_lds_dwordx4 v15, s[28:29] offset:3072
    v_exp_f32 v100, v100
    v_exp_f32 v101, v101
    v_exp_f32 v102, v102
    v_exp_f32 v103, v103
    v_mfma_f32_32x32x16_bf16 v[64:79], a[100:103], a[140:143], v[64:79]
    s_add_u32 s28, s28, 28672
    s_addc_u32 s29, s29, 0
    v_exp_f32 v104, v104
    v_exp_f32 v105, v105
    v_exp_f32 v106, v106
    v_exp_f32 v107, v107
    v_smfmac_f32_32x32x32_bf16 v[32:47], a[88:91], v[96:103], v8
    v_exp_f32 v108, v108
    v_exp_f32 v109, v109
    v_exp_f32 v110, v110
    v_exp_f32 v111, v111
    v_mfma_f32_32x32x16_bf16 v[80:95], a[96:99], a[144:147], 0
    v_exp_f32 v48, v48
    v_exp_f32 v49, v49
    v_exp_f32 v50, v50
    v_exp_f32 v51, v51
    v_smfmac_f32_32x32x32_bf16 v[32:47], a[92:95], v[104:111], v8
    v_exp_f32 v52, v52
    v_exp_f32 v53, v53
    v_exp_f32 v54, v54
    v_exp_f32 v55, v55
    v_mfma_f32_32x32x16_bf16 v[80:95], a[100:103], a[148:151], v[80:95]
    v_exp_f32 v56, v56
    v_exp_f32 v57, v57
    v_exp_f32 v58, v58
    v_exp_f32 v59, v59
    v_smfmac_f32_32x32x32_bf16 a[0:15], a[104:107], v[48:55], v8
    v_exp_f32 v60, v60
    v_exp_f32 v61, v61
    v_exp_f32 v62, v62
    v_exp_f32 v63, v63
    v_mfma_f32_32x32x16_bf16 v[96:111], a[96:99], a[152:155], 0
    v_exp_f32 v64, v64
    v_exp_f32 v65, v65
    v_exp_f32 v66, v66
    v_exp_f32 v67, v67
    v_smfmac_f32_32x32x32_bf16 a[0:15], a[108:111], v[56:63], v8
    global_load_dwordx4 a[80:83], v7, s[0:1] offset:0 sc1
    global_load_dwordx4 a[84:87], v7, s[0:1] offset:1024 sc1
    global_load_dwordx4 a[88:91], v7, s[0:1] offset:2048 sc1
    global_load_dwordx4 a[92:95], v7, s[0:1] offset:3072 sc1
    s_add_u32 s0, s0, 4352
    s_addc_u32 s1, s1, 0
    v_exp_f32 v68, v68
    v_exp_f32 v69, v69
    v_exp_f32 v70, v70
    v_exp_f32 v71, v71
    v_mfma_f32_32x32x16_bf16 v[96:111], a[100:103], a[156:159], v[96:111]
    s_waitcnt vmcnt(10)
    s_lshl_b32 s57, s50, 10
    v_cvt_pk_bf16_f32 v128, v128, v129
    v_cvt_pk_bf16_f32 v129, v130, v131
    v_cvt_pk_bf16_f32 v130, v132, v133
    v_cvt_pk_bf16_f32 v131, v134, v135
    v_subrev_u32 v3, s57, v22
    v_add_u32 v4, 114688, v7
    ds_write_b128 v3, v[128:131]
    v_exp_f32 v72, v72
    v_exp_f32 v73, v73
    v_exp_f32 v74, v74
    v_exp_f32 v75, v75
    v_smfmac_f32_32x32x32_bf16 a[16:31], a[104:107], v[64:71], v8
    v_exp_f32 v76, v76
    v_exp_f32 v77, v77
    v_exp_f32 v78, v78
    v_exp_f32 v79, v79
    v_mfma_f32_32x32x16_bf16 v[48:63], a[112:115], a[128:131], 0
    v_exp_f32 v80, v80
    v_exp_f32 v81, v81
    v_exp_f32 v82, v82
    v_exp_f32 v83, v83
    v_smfmac_f32_32x32x32_bf16 a[16:31], a[108:111], v[72:79], v8
    v_exp_f32 v84, v84
    v_exp_f32 v85, v85
    v_exp_f32 v86, v86
    v_exp_f32 v87, v87
    v_mfma_f32_32x32x16_bf16 v[48:63], a[116:119], a[132:135], v[48:63]
    v_exp_f32 v88, v88
    v_exp_f32 v89, v89
    v_exp_f32 v90, v90
    v_exp_f32 v91, v91
    v_smfmac_f32_32x32x32_bf16 a[32:47], a[104:107], v[80:87], v8
    v_exp_f32 v92, v92
    v_exp_f32 v93, v93
    v_exp_f32 v94, v94
    v_exp_f32 v95, v95
    v_mfma_f32_32x32x16_bf16 v[64:79], a[112:115], a[136:139], 0
    s_add_u32 m0, s15, 14336
    v_exp_f32 v96, v96
    v_exp_f32 v97, v97
    v_exp_f32 v98, v98
    v_exp_f32 v99, v99
    v_smfmac_f32_32x32x32_bf16 a[32:47], a[108:111], v[88:95], v8
    global_load_lds_dwordx4 v12, s[30:31] offset:0
    global_load_lds_dwordx4 v13, s[30:31] offset:1024
    v_exp_f32 v100, v100
    v_exp_f32 v101, v101
    v_exp_f32 v102, v102
    v_exp_f32 v103, v103
    v_mfma_f32_32x32x16_bf16 v[64:79], a[116:119], a[140:143], v[64:79]
    s_waitcnt lgkmcnt(0)
    s_barrier
    ds_read_b128 v[136:139], v4 offset:0
    ds_read_b128 v[140:143], v4 offset:1024
    ds_read_b128 v[144:147], v4 offset:2048
    ds_read_b128 v[148:151], v4 offset:3072
    v_exp_f32 v104, v104
    v_exp_f32 v105, v105
    v_exp_f32 v106, v106
    v_exp_f32 v107, v107
    v_smfmac_f32_32x32x32_bf16 v[32:47], a[104:107], v[96:103], v8
    v_exp_f32 v108, v108
    v_exp_f32 v109, v109
    v_exp_f32 v110, v110
    v_exp_f32 v111, v111
    v_mfma_f32_32x32x16_bf16 v[80:95], a[112:115], a[144:147], 0
    v_exp_f32 v48, v48
    v_exp_f32 v49, v49
    v_exp_f32 v50, v50
    v_exp_f32 v51, v51
    v_smfmac_f32_32x32x32_bf16 v[32:47], a[108:111], v[104:111], v8
    v_exp_f32 v52, v52
    v_exp_f32 v53, v53
    v_exp_f32 v54, v54
    v_exp_f32 v55, v55
    v_mfma_f32_32x32x16_bf16 v[80:95], a[116:119], a[148:151], v[80:95]
    v_exp_f32 v56, v56
    v_exp_f32 v57, v57
    v_exp_f32 v58, v58
    v_exp_f32 v59, v59
    v_smfmac_f32_32x32x32_bf16 a[0:15], a[120:123], v[48:55], v8
    v_exp_f32 v60, v60
    v_exp_f32 v61, v61
    v_exp_f32 v62, v62
    v_exp_f32 v63, v63
    v_mfma_f32_32x32x16_bf16 v[96:111], a[112:115], a[152:155], 0
    s_waitcnt lgkmcnt(0)
    v_exp_f32 v64, v64
    v_exp_f32 v65, v65
    v_exp_f32 v66, v66
    v_exp_f32 v67, v67
    v_smfmac_f32_32x32x32_bf16 a[0:15], a[124:127], v[56:63], v8
    global_load_dwordx4 a[96:99], v7, s[0:1] offset:0 sc1
    global_load_dwordx4 a[100:103], v7, s[0:1] offset:1024 sc1
    global_load_dwordx4 a[104:107], v7, s[0:1] offset:2048 sc1
    global_load_dwordx4 a[108:111], v7, s[0:1] offset:3072 sc1
    s_add_u32 s0, s0, 4352
    s_addc_u32 s1, s1, 0
    v_exp_f32 v68, v68
    v_exp_f32 v69, v69
    v_exp_f32 v70, v70
    v_exp_f32 v71, v71
    v_mfma_f32_32x32x16_bf16 v[96:111], a[116:119], a[156:159], v[96:111]
    v_exp_f32 v72, v72
    v_exp_f32 v73, v73
    v_mfma_f32_32x32x16_bf16 v[152:167], v[136:139], v[224:227], 0
    v_exp_f32 v74, v74
    v_exp_f32 v75, v75
    v_smfmac_f32_32x32x32_bf16 a[16:31], a[120:123], v[64:71], v8
    s_waitcnt vmcnt(12)
    v_exp_f32 v76, v76
    v_exp_f32 v77, v77
    v_exp_f32 v78, v78
    v_exp_f32 v79, v79
    v_mfma_f32_32x32x16_bf16 v[48:63], a[64:67], a[128:131], 0
    v_exp_f32 v80, v80
    v_exp_f32 v81, v81
    v_exp_f32 v82, v82
    v_exp_f32 v83, v83
    v_smfmac_f32_32x32x32_bf16 a[16:31], a[124:127], v[72:79], v8
    v_exp_f32 v84, v84
    v_exp_f32 v85, v85
    v_exp_f32 v86, v86
    v_exp_f32 v87, v87
    v_mfma_f32_32x32x16_bf16 v[48:63], a[68:71], a[132:135], v[48:63]
    v_exp_f32 v88, v88
    v_exp_f32 v89, v89
    v_mfma_f32_32x32x16_bf16 v[152:167], v[140:143], v[228:231], v[152:167]
    v_exp_f32 v90, v90
    v_exp_f32 v91, v91
    v_smfmac_f32_32x32x32_bf16 a[32:47], a[120:123], v[80:87], v8
    v_exp_f32 v92, v92
    v_exp_f32 v93, v93
    v_exp_f32 v94, v94
    v_exp_f32 v95, v95
    v_mfma_f32_32x32x16_bf16 v[64:79], a[64:67], a[136:139], 0
    v_exp_f32 v96, v96
    v_exp_f32 v97, v97
    v_exp_f32 v98, v98
    v_exp_f32 v99, v99
    v_smfmac_f32_32x32x32_bf16 a[32:47], a[124:127], v[88:95], v8
    global_load_lds_dwordx4 v14, s[30:31] offset:2048
    global_load_lds_dwordx4 v15, s[30:31] offset:3072
    v_exp_f32 v100, v100
    v_exp_f32 v101, v101
    v_exp_f32 v102, v102
    v_exp_f32 v103, v103
    v_mfma_f32_32x32x16_bf16 v[64:79], a[68:71], a[140:143], v[64:79]
    s_add_u32 s30, s30, 28672
    s_addc_u32 s31, s31, 0
    v_exp_f32 v104, v104
    v_exp_f32 v105, v105
    v_mfma_f32_32x32x16_bf16 v[152:167], v[144:147], v[232:235], v[152:167]
    v_exp_f32 v106, v106
    v_exp_f32 v107, v107
    v_smfmac_f32_32x32x32_bf16 v[32:47], a[120:123], v[96:103], v8
    s_add_u32 s15, s15, 4096
    v_exp_f32 v108, v108
    v_exp_f32 v109, v109
    v_exp_f32 v110, v110
    v_exp_f32 v111, v111
    v_mfma_f32_32x32x16_bf16 v[80:95], a[64:67], a[144:147], 0
    v_exp_f32 v48, v48
    v_exp_f32 v49, v49
    v_exp_f32 v50, v50
    v_exp_f32 v51, v51
    v_smfmac_f32_32x32x32_bf16 v[32:47], a[124:127], v[104:111], v8
    v_exp_f32 v52, v52
    v_exp_f32 v53, v53
    v_exp_f32 v54, v54
    v_exp_f32 v55, v55
    v_mfma_f32_32x32x16_bf16 v[80:95], a[68:71], a[148:151], v[80:95]
    v_exp_f32 v56, v56
    v_exp_f32 v57, v57
    v_mfma_f32_32x32x16_bf16 v[152:167], v[148:151], v[236:239], v[152:167]
    v_exp_f32 v58, v58
    v_exp_f32 v59, v59
    v_smfmac_f32_32x32x32_bf16 a[0:15], a[72:75], v[48:55], v8
    v_exp_f32 v60, v60
    v_exp_f32 v61, v61
    v_exp_f32 v62, v62
    v_exp_f32 v63, v63
    v_mfma_f32_32x32x16_bf16 v[96:111], a[64:67], a[152:155], 0
    v_exp_f32 v64, v64
    v_exp_f32 v65, v65
    v_exp_f32 v66, v66
    v_exp_f32 v67, v67
    v_smfmac_f32_32x32x32_bf16 a[0:15], a[76:79], v[56:63], v8
    global_load_dwordx4 a[112:115], v7, s[0:1] offset:0 sc1
    global_load_dwordx4 a[116:119], v7, s[0:1] offset:1024 sc1
    global_load_dwordx4 a[120:123], v7, s[0:1] offset:2048 sc1
    global_load_dwordx4 a[124:127], v7, s[0:1] offset:3072 sc1
    v_exp_f32 v68, v68
    v_exp_f32 v69, v69
    v_exp_f32 v70, v70
    v_exp_f32 v71, v71
    v_mfma_f32_32x32x16_bf16 v[96:111], a[68:71], a[156:159], v[96:111]
    v_exp_f32 v72, v72
    v_exp_f32 v73, v73
    v_exp_f32 v74, v74
    v_exp_f32 v75, v75
    v_smfmac_f32_32x32x32_bf16 a[16:31], a[72:75], v[64:71], v8
    s_waitcnt vmcnt(12)
    v_exp_f32 v76, v76
    v_exp_f32 v77, v77
    v_exp_f32 v78, v78
    v_exp_f32 v79, v79
    v_mfma_f32_32x32x16_bf16 v[48:63], a[80:83], a[128:131], 0
    v_exp_f32 v80, v80
    v_exp_f32 v81, v81
    v_exp_f32 v82, v82
    v_exp_f32 v83, v83
    v_smfmac_f32_32x32x32_bf16 a[16:31], a[76:79], v[72:79], v8
    v_exp_f32 v84, v84
    v_exp_f32 v85, v85
    v_exp_f32 v86, v86
    v_exp_f32 v87, v87
    v_mfma_f32_32x32x16_bf16 v[48:63], a[84:87], a[132:135], v[48:63]
    v_mov_b32 v3, v164
    v_mov_b32 v4, v164
    v_mov_b32 v5, v11
    s_nop 0
    v_permlane32_swap_b32 v3, v4
    v_add_f32 v4, 0x358637bd, v4
    v_rcp_f32 v4, v4
    s_nop 0
    v_mul_f32 v168, v4, v5
    v_mul_f32 v152, v168, v152
    v_mul_f32 v153, v168, v153
    v_mul_f32 v154, v168, v154
    v_mul_f32 v155, v168, v155
    v_mul_f32 v156, v168, v156
    v_mul_f32 v157, v168, v157
    v_mul_f32 v158, v168, v158
    v_mul_f32 v159, v168, v159
    v_mul_f32 v160, v168, v160
    v_mul_f32 v161, v168, v161
    v_mul_f32 v162, v168, v162
    v_mul_f32 v163, v168, v163
    v_mul_f32 v164, v168, v164
    v_mul_f32 v165, v168, v165
    v_mul_f32 v166, v168, v166
    v_mul_f32 v167, v168, v167
    v_cvt_pk_bf16_f32 v152, v152, v153
    v_cvt_pk_bf16_f32 v153, v154, v155
    v_cvt_pk_bf16_f32 v154, v156, v157
    v_cvt_pk_bf16_f32 v155, v158, v159
    v_cvt_pk_bf16_f32 v156, v160, v161
    v_cvt_pk_bf16_f32 v157, v162, v163
    v_cvt_pk_bf16_f32 v158, v164, v165
    v_cvt_pk_bf16_f32 v159, v166, v167
    v_and_b32 v158, v158, v10
    v_and_b32 v159, v159, v10
    v_exp_f32 v88, v88
    v_exp_f32 v89, v89
    v_exp_f32 v90, v90
    v_exp_f32 v91, v91
    v_smfmac_f32_32x32x32_bf16 a[32:47], a[72:75], v[80:87], v8
    buffer_store_dwordx4 v[152:155], v7, s[36:39], s8 offen sc1
    buffer_store_dwordx4 v[156:159], v7, s[36:39], s8 offen offset:1024 sc1
    v_exp_f32 v92, v92
    v_exp_f32 v93, v93
    v_exp_f32 v94, v94
    v_exp_f32 v95, v95
    v_mfma_f32_32x32x16_bf16 v[64:79], a[80:83], a[136:139], 0
    s_add_u32 m0, s15, 0
    v_exp_f32 v96, v96
    v_exp_f32 v97, v97
    v_exp_f32 v98, v98
    v_exp_f32 v99, v99
    v_smfmac_f32_32x32x32_bf16 a[32:47], a[76:79], v[88:95], v8
    global_load_lds_dwordx4 v12, s[28:29] offset:0
    global_load_lds_dwordx4 v13, s[28:29] offset:1024
    v_exp_f32 v100, v100
    v_exp_f32 v101, v101
    v_exp_f32 v102, v102
    v_exp_f32 v103, v103
    v_mfma_f32_32x32x16_bf16 v[64:79], a[84:87], a[140:143], v[64:79]
    v_exp_f32 v104, v104
    v_exp_f32 v105, v105
    v_exp_f32 v106, v106
    v_exp_f32 v107, v107
    v_smfmac_f32_32x32x32_bf16 v[32:47], a[72:75], v[96:103], v8
    v_exp_f32 v108, v108
    v_exp_f32 v109, v109
    v_exp_f32 v110, v110
    v_exp_f32 v111, v111
    v_mfma_f32_32x32x16_bf16 v[80:95], a[80:83], a[144:147], 0
    v_exp_f32 v48, v48
    v_exp_f32 v49, v49
    v_exp_f32 v50, v50
    v_exp_f32 v51, v51
    v_smfmac_f32_32x32x32_bf16 v[32:47], a[76:79], v[104:111], v8
    v_exp_f32 v52, v52
    v_exp_f32 v53, v53
    v_exp_f32 v54, v54
    v_exp_f32 v55, v55
    v_mfma_f32_32x32x16_bf16 v[80:95], a[84:87], a[148:151], v[80:95]
    v_exp_f32 v56, v56
    v_exp_f32 v57, v57
    v_exp_f32 v58, v58
    v_exp_f32 v59, v59
    v_smfmac_f32_32x32x32_bf16 a[0:15], a[88:91], v[48:55], v8
    v_exp_f32 v60, v60
    v_exp_f32 v61, v61
    v_exp_f32 v62, v62
    v_exp_f32 v63, v63
    v_mfma_f32_32x32x16_bf16 v[96:111], a[80:83], a[152:155], 0
    v_exp_f32 v64, v64
    v_exp_f32 v65, v65
    v_exp_f32 v66, v66
    v_exp_f32 v67, v67
    v_smfmac_f32_32x32x32_bf16 a[0:15], a[92:95], v[56:63], v8
    v_exp_f32 v68, v68
    v_exp_f32 v69, v69
    v_exp_f32 v70, v70
    v_exp_f32 v71, v71
    v_mfma_f32_32x32x16_bf16 v[96:111], a[84:87], a[156:159], v[96:111]
    v_exp_f32 v72, v72
    v_exp_f32 v73, v73
    v_exp_f32 v74, v74
    v_exp_f32 v75, v75
    v_smfmac_f32_32x32x32_bf16 a[16:31], a[88:91], v[64:71], v8
    s_waitcnt vmcnt(10)
    v_exp_f32 v76, v76
    v_exp_f32 v77, v77
    v_exp_f32 v78, v78
    v_exp_f32 v79, v79
    v_mfma_f32_32x32x16_bf16 v[48:63], a[96:99], a[128:131], 0
    v_exp_f32 v80, v80
    v_exp_f32 v81, v81
    v_exp_f32 v82, v82
    v_exp_f32 v83, v83
    v_smfmac_f32_32x32x32_bf16 a[16:31], a[92:95], v[72:79], v8
    v_exp_f32 v84, v84
    v_exp_f32 v85, v85
    v_exp_f32 v86, v86
    v_exp_f32 v87, v87
    v_mfma_f32_32x32x16_bf16 v[48:63], a[100:103], a[132:135], v[48:63]
    v_exp_f32 v88, v88
    v_exp_f32 v89, v89
    v_exp_f32 v90, v90
    v_exp_f32 v91, v91
    v_smfmac_f32_32x32x32_bf16 a[32:47], a[88:91], v[80:87], v8
    v_exp_f32 v92, v92
    v_exp_f32 v93, v93
    v_exp_f32 v94, v94
    v_exp_f32 v95, v95
    v_mfma_f32_32x32x16_bf16 v[64:79], a[96:99], a[136:139], 0
    s_add_u32 m0, s15, 14336
    v_exp_f32 v96, v96
    v_exp_f32 v97, v97
    v_exp_f32 v98, v98
    v_exp_f32 v99, v99
    v_smfmac_f32_32x32x32_bf16 a[32:47], a[92:95], v[88:95], v8
    global_load_lds_dwordx4 v12, s[30:31] offset:0
    global_load_lds_dwordx4 v13, s[30:31] offset:1024
    v_exp_f32 v100, v100
    v_exp_f32 v101, v101
    v_exp_f32 v102, v102
    v_exp_f32 v103, v103
    v_mfma_f32_32x32x16_bf16 v[64:79], a[100:103], a[140:143], v[64:79]
    v_exp_f32 v104, v104
    v_exp_f32 v105, v105
    v_exp_f32 v106, v106
    v_exp_f32 v107, v107
    v_smfmac_f32_32x32x32_bf16 v[32:47], a[88:91], v[96:103], v8
    v_exp_f32 v108, v108
    v_exp_f32 v109, v109
    v_exp_f32 v110, v110
    v_exp_f32 v111, v111
    v_mfma_f32_32x32x16_bf16 v[80:95], a[96:99], a[144:147], 0
    s_waitcnt vmcnt(4)
    s_barrier
    v_exp_f32 v48, v48
    v_exp_f32 v49, v49
    v_exp_f32 v50, v50
    v_exp_f32 v51, v51
    v_smfmac_f32_32x32x32_bf16 v[32:47], a[92:95], v[104:111], v8
    v_exp_f32 v52, v52
    v_exp_f32 v53, v53
    v_exp_f32 v54, v54
    v_exp_f32 v55, v55
    v_mfma_f32_32x32x16_bf16 v[80:95], a[100:103], a[148:151], v[80:95]
    s_mov_b64 exec, 0xff
    buffer_store_dwordx4 v[252:255], v7, s[36:39], s6 offen sc1
    s_mov_b64 exec, -1
    v_exp_f32 v56, v56
    v_exp_f32 v57, v57
    v_exp_f32 v58, v58
    v_exp_f32 v59, v59
    v_smfmac_f32_32x32x32_bf16 a[0:15], a[104:107], v[48:55], v8
    s_add_u32 s8, s8, 32768
    v_exp_f32 v60, v60
    v_exp_f32 v61, v61
    v_exp_f32 v62, v62
    v_exp_f32 v63, v63
    v_mfma_f32_32x32x16_bf16 v[96:111], a[96:99], a[152:155], 0
    v_exp_f32 v64, v64
    v_exp_f32 v65, v65
    v_exp_f32 v66, v66
    v_exp_f32 v67, v67
    v_smfmac_f32_32x32x32_bf16 a[0:15], a[108:111], v[56:63], v8
    v_exp_f32 v68, v68
    v_exp_f32 v69, v69
    v_exp_f32 v70, v70
    v_exp_f32 v71, v71
    v_mfma_f32_32x32x16_bf16 v[96:111], a[100:103], a[156:159], v[96:111]
    v_exp_f32 v72, v72
    v_exp_f32 v73, v73
    v_exp_f32 v74, v74
    v_exp_f32 v75, v75
    v_smfmac_f32_32x32x32_bf16 a[16:31], a[104:107], v[64:71], v8
    v_exp_f32 v76, v76
    v_exp_f32 v77, v77
    v_exp_f32 v78, v78
    v_exp_f32 v79, v79
    v_mfma_f32_32x32x16_bf16 v[48:63], a[112:115], a[128:131], 0
    v_exp_f32 v80, v80
    v_exp_f32 v81, v81
    v_exp_f32 v82, v82
    v_exp_f32 v83, v83
    v_smfmac_f32_32x32x32_bf16 a[16:31], a[108:111], v[72:79], v8
    v_exp_f32 v84, v84
    v_exp_f32 v85, v85
    v_exp_f32 v86, v86
    v_exp_f32 v87, v87
    v_mfma_f32_32x32x16_bf16 v[48:63], a[116:119], a[132:135], v[48:63]
    v_exp_f32 v88, v88
    v_exp_f32 v89, v89
    v_exp_f32 v90, v90
    v_exp_f32 v91, v91
    v_smfmac_f32_32x32x32_bf16 a[32:47], a[104:107], v[80:87], v8
    v_exp_f32 v92, v92
    v_exp_f32 v93, v93
    v_exp_f32 v94, v94
    v_exp_f32 v95, v95
    v_mfma_f32_32x32x16_bf16 v[64:79], a[112:115], a[136:139], 0
    v_exp_f32 v96, v96
    v_exp_f32 v97, v97
    v_exp_f32 v98, v98
    v_exp_f32 v99, v99
    v_smfmac_f32_32x32x32_bf16 a[32:47], a[108:111], v[88:95], v8
    v_exp_f32 v100, v100
    v_exp_f32 v101, v101
    v_exp_f32 v102, v102
    v_exp_f32 v103, v103
    v_mfma_f32_32x32x16_bf16 v[64:79], a[116:119], a[140:143], v[64:79]
    v_exp_f32 v104, v104
    v_exp_f32 v105, v105
    v_exp_f32 v106, v106
    v_exp_f32 v107, v107
    v_smfmac_f32_32x32x32_bf16 v[32:47], a[104:107], v[96:103], v8
    v_exp_f32 v108, v108
    v_exp_f32 v109, v109
    v_exp_f32 v110, v110
    v_exp_f32 v111, v111
    v_mfma_f32_32x32x16_bf16 v[80:95], a[112:115], a[144:147], 0
    v_exp_f32 v48, v48
    v_exp_f32 v49, v49
    v_exp_f32 v50, v50
    v_exp_f32 v51, v51
    v_smfmac_f32_32x32x32_bf16 v[32:47], a[108:111], v[104:111], v8
    v_exp_f32 v52, v52
    v_exp_f32 v53, v53
    v_exp_f32 v54, v54
    v_exp_f32 v55, v55
    v_mfma_f32_32x32x16_bf16 v[80:95], a[116:119], a[148:151], v[80:95]
    v_exp_f32 v56, v56
    v_exp_f32 v57, v57
    v_exp_f32 v58, v58
    v_exp_f32 v59, v59
    v_smfmac_f32_32x32x32_bf16 a[0:15], a[120:123], v[48:55], v8
    v_exp_f32 v60, v60
    v_exp_f32 v61, v61
    v_exp_f32 v62, v62
    v_exp_f32 v63, v63
    v_mfma_f32_32x32x16_bf16 v[96:111], a[112:115], a[152:155], 0
    v_exp_f32 v64, v64
    v_exp_f32 v65, v65
    v_exp_f32 v66, v66
    v_exp_f32 v67, v67
    v_smfmac_f32_32x32x32_bf16 a[0:15], a[124:127], v[56:63], v8
    v_exp_f32 v68, v68
    v_exp_f32 v69, v69
    v_exp_f32 v70, v70
    v_exp_f32 v71, v71
    v_mfma_f32_32x32x16_bf16 v[96:111], a[116:119], a[156:159], v[96:111]
    v_exp_f32 v72, v72
    v_exp_f32 v73, v73
    v_exp_f32 v74, v74
    v_exp_f32 v75, v75
    v_smfmac_f32_32x32x32_bf16 a[16:31], a[120:123], v[64:71], v8
    v_exp_f32 v76, v76
    v_exp_f32 v77, v77
    v_exp_f32 v78, v78
    v_exp_f32 v79, v79
    ds_write_b128 v23, a[0:3] offset:0
    v_exp_f32 v80, v80
    v_exp_f32 v81, v81
    v_exp_f32 v82, v82
    v_exp_f32 v83, v83
    v_smfmac_f32_32x32x32_bf16 a[16:31], a[124:127], v[72:79], v8
    ds_write_b128 v23, a[4:7] offset:1024
    v_exp_f32 v84, v84
    v_exp_f32 v85, v85
    v_exp_f32 v86, v86
    v_exp_f32 v87, v87
    ds_write_b128 v23, a[8:11] offset:2048
    v_exp_f32 v88, v88
    v_exp_f32 v89, v89
    v_exp_f32 v90, v90
    v_exp_f32 v91, v91
    v_smfmac_f32_32x32x32_bf16 a[32:47], a[120:123], v[80:87], v8
    ds_write_b128 v23, a[12:15] offset:3072
    v_exp_f32 v92, v92
    v_exp_f32 v93, v93
    v_exp_f32 v94, v94
    v_exp_f32 v95, v95
    ds_write_b128 v24, a[16:19] offset:0
    v_exp_f32 v96, v96
    v_exp_f32 v97, v97
    v_exp_f32 v98, v98
    v_exp_f32 v99, v99
    v_smfmac_f32_32x32x32_bf16 a[32:47], a[124:127], v[88:95], v8
    ds_write_b128 v24, a[20:23] offset:1024
    v_exp_f32 v100, v100
    v_exp_f32 v101, v101
    v_exp_f32 v102, v102
    v_exp_f32 v103, v103
    ds_write_b128 v24, a[24:27] offset:2048
    buffer_load_dwordx2 v[248:249], v18, s[36:39], s18 offen sc1
    v_exp_f32 v104, v104
    v_exp_f32 v105, v105
    v_exp_f32 v106, v106
    v_exp_f32 v107, v107
    v_smfmac_f32_32x32x32_bf16 v[32:47], a[120:123], v[96:103], v8
    ds_write_b128 v24, a[28:31] offset:3072
    v_exp_f32 v108, v108
    v_exp_f32 v109, v109
    v_exp_f32 v110, v110
    v_exp_f32 v111, v111
    ds_write_b128 v25, a[32:35] offset:0
    ds_write_b128 v25, a[36:39] offset:1024
    v_smfmac_f32_32x32x32_bf16 v[32:47], a[124:127], v[104:111], v8
    ds_write_b128 v25, a[40:43] offset:2048
    ds_write_b128 v25, a[44:47] offset:3072
    s_waitcnt lgkmcnt(0)
    s_barrier
    ds_read_b128 v[48:51], v26 offset:0
    ds_read_b128 v[52:55], v26 offset:1024
    ds_read_b128 v[56:59], v26 offset:2048
    ds_read_b128 v[60:63], v26 offset:3072
    ds_read_b128 v[64:67], v26 offset:4096
    ds_read_b128 v[68:71], v26 offset:5120
    ds_read_b128 v[72:75], v26 offset:6144
    ds_read_b128 v[76:79], v26 offset:7168
    ds_read_b128 v[80:83], v26 offset:8192
    ds_read_b128 v[84:87], v26 offset:9216
    ds_read_b128 v[88:91], v26 offset:10240
    ds_read_b128 v[92:95], v26 offset:11264
    s_waitcnt lgkmcnt(8)
    v_pk_add_f32 v[32:33], v[32:33], v[48:49]
    v_pk_add_f32 v[34:35], v[34:35], v[50:51]
    v_pk_add_f32 v[36:37], v[36:37], v[52:53]
    v_pk_add_f32 v[38:39], v[38:39], v[54:55]
    v_pk_add_f32 v[40:41], v[40:41], v[56:57]
    v_pk_add_f32 v[42:43], v[42:43], v[58:59]
    v_pk_add_f32 v[44:45], v[44:45], v[60:61]
    v_pk_add_f32 v[46:47], v[46:47], v[62:63]
    s_waitcnt lgkmcnt(4)
    v_pk_add_f32 v[32:33], v[32:33], v[64:65]
    v_pk_add_f32 v[34:35], v[34:35], v[66:67]
    v_pk_add_f32 v[36:37], v[36:37], v[68:69]
    v_pk_add_f32 v[38:39], v[38:39], v[70:71]
    v_pk_add_f32 v[40:41], v[40:41], v[72:73]
    v_pk_add_f32 v[42:43], v[42:43], v[74:75]
    v_pk_add_f32 v[44:45], v[44:45], v[76:77]
    v_pk_add_f32 v[46:47], v[46:47], v[78:79]
    s_waitcnt lgkmcnt(0)
    v_pk_add_f32 v[32:33], v[32:33], v[80:81]
    v_pk_add_f32 v[34:35], v[34:35], v[82:83]
    v_pk_add_f32 v[36:37], v[36:37], v[84:85]
    v_pk_add_f32 v[38:39], v[38:39], v[86:87]
    v_pk_add_f32 v[40:41], v[40:41], v[88:89]
    v_pk_add_f32 v[42:43], v[42:43], v[90:91]
    v_pk_add_f32 v[44:45], v[44:45], v[92:93]
    v_pk_add_f32 v[46:47], v[46:47], v[94:95]
    v_pk_mul_f32 v[168:169], v[32:33], 0
    v_pk_fma_f32 v[168:169], v[34:35], 0, v[168:169]
    v_pk_fma_f32 v[168:169], v[36:37], 0, v[168:169]
    v_pk_fma_f32 v[168:169], v[38:39], 0, v[168:169]
    v_pk_fma_f32 v[168:169], v[40:41], 0, v[168:169]
    v_pk_fma_f32 v[168:169], v[42:43], 0, v[168:169]
    v_pk_fma_f32 v[168:169], v[44:45], 0, v[168:169]
    v_pk_fma_f32 v[168:169], v[46:47], 0, v[168:169]
    v_cmp_u_f32 vcc, v168, v169
    v_mov_b32 v3, v44
    v_mov_b32 v4, v44
    v_sub_f32 v5, 1.0, v11
    s_nop 0
    v_permlane32_swap_b32 v3, v4
    v_rcp_f32 v4, v4
    s_nop 0
    v_mul_f32 v168, v4, v5
    s_cbranch_vccnz L2_fallback
L2_fin:
    v_pk_mul_f32 v[32:33], v[32:33], v[168:169] op_sel_hi:[1,0]
    v_pk_mul_f32 v[34:35], v[34:35], v[168:169] op_sel_hi:[1,0]
    v_pk_mul_f32 v[36:37], v[36:37], v[168:169] op_sel_hi:[1,0]
    v_pk_mul_f32 v[38:39], v[38:39], v[168:169] op_sel_hi:[1,0]
    v_pk_mul_f32 v[40:41], v[40:41], v[168:169] op_sel_hi:[1,0]
    v_pk_mul_f32 v[42:43], v[42:43], v[168:169] op_sel_hi:[1,0]
    v_pk_mul_f32 v[44:45], v[44:45], v[168:169] op_sel_hi:[1,0]
    v_pk_mul_f32 v[46:47], v[46:47], v[168:169] op_sel_hi:[1,0]
    v_cvt_pk_bf16_f32 v32, v32, v33
    v_cvt_pk_bf16_f32 v33, v34, v35
    s_waitcnt vmcnt(0)
    v_cmp_ne_u64 vcc, s[64:65], v[248:249]
    v_cvt_pk_bf16_f32 v34, v36, v37
    v_cvt_pk_bf16_f32 v35, v38, v39
    v_cvt_pk_bf16_f32 v36, v40, v41
    v_cvt_pk_bf16_f32 v37, v42, v43
    v_cvt_pk_bf16_f32 v38, v44, v45
    v_cvt_pk_bf16_f32 v39, v46, v47
    v_and_b32 v38, v38, v10
    v_and_b32 v39, v39, v10
    buffer_store_dwordx4 v[32:35], v7, s[36:39], s8 offen sc1
    buffer_store_dwordx4 v[36:39], v7, s[36:39], s8 offen offset:1024 sc1
    s_cmp_ge_u32 s61, 28
    s_cbranch_scc1 L_nop3
    s_cbranch_vccnz L_pa_s
L_pa_ok:
    s_add_u32 s18, s18, 32768
    buffer_load_dwordx4 a[160:163], v7, s[36:39], s22 offen offset:0 sc1
    buffer_load_dwordx4 a[164:167], v7, s[36:39], s23 offen offset:0 sc1
    buffer_load_dwordx4 a[168:171], v7, s[36:39], s22 offen offset:1024 sc1
    buffer_load_dwordx4 a[172:175], v7, s[36:39], s23 offen offset:1024 sc1
    buffer_load_dwordx4 a[176:179], v7, s[36:39], s22 offen offset:2048 sc1
    buffer_load_dwordx4 a[180:183], v7, s[36:39], s23 offen offset:2048 sc1
    buffer_load_dwordx4 a[184:187], v7, s[36:39], s22 offen offset:3072 sc1
    buffer_load_dwordx4 a[188:191], v7, s[36:39], s23 offen offset:3072 sc1
    s_add_u32 s22, s22, 4096
    s_add_u32 s23, s23, 4096
    ds_read_b64_tr_b16 v[112:113], v27 offset:0
    ds_read_b64_tr_b16 v[114:115], v27 offset:1024
    ds_read_b64_tr_b16 v[116:117], v28 offset:0
    ds_read_b64_tr_b16 v[118:119], v28 offset:1024
    s_waitcnt vmcnt(8)
    s_barrier
    s_mov_b64 exec, 0xff
    buffer_store_dwordx4 v[252:255], v7, s[36:39], s7 offen sc1
    s_mov_b64 exec, -1
    s_waitcnt vmcnt(7) lgkmcnt(0)
    v_mfma_f32_32x32x16_bf16 v[48:63], v[112:115], a[160:163], 0
    ds_read_b64_tr_b16 v[120:121], v27 offset:2048
    ds_read_b64_tr_b16 v[122:123], v27 offset:3072
    ds_read_b64_tr_b16 v[124:125], v28 offset:2048
    ds_read_b64_tr_b16 v[126:127], v28 offset:3072
    v_mfma_f32_32x32x16_bf16 v[64:79], v[116:119], a[160:163], 0
    buffer_load_dwordx4 a[192:195], v7, s[36:39], s22 offen offset:0 sc1
    buffer_load_dwordx4 a[196:199], v7, s[36:39], s23 offen offset:0 sc1
    v_mfma_f32_32x32x16_bf16 v[80:95], v[112:115], a[164:167], 0
    v_mfma_f32_32x32x16_bf16 v[96:111], v[116:119], a[164:167], 0
    s_waitcnt vmcnt(7) lgkmcnt(0)
    v_mfma_f32_32x32x16_bf16 v[48:63], v[120:123], a[168:171], v[48:63]
    ds_read_b64_tr_b16 v[112:113], v27 offset:3584
    ds_read_b64_tr_b16 v[114:115], v27 offset:4608
    ds_read_b64_tr_b16 v[116:117], v28 offset:3584
    ds_read_b64_tr_b16 v[118:119], v28 offset:4608
    v_mfma_f32_32x32x16_bf16 v[64:79], v[124:127], a[168:171], v[64:79]
    buffer_load_dwordx4 a[200:203], v7, s[36:39], s22 offen offset:1024 sc1
    buffer_load_dwordx4 a[204:207], v7, s[36:39], s23 offen offset:1024 sc1
    v_mfma_f32_32x32x16_bf16 v[80:95], v[120:123], a[172:175], v[80:95]
    v_mfma_f32_32x32x16_bf16 v[96:111], v[124:127], a[172:175], v[96:111]
    s_waitcnt vmcnt(7) lgkmcnt(0)
    v_mfma_f32_32x32x16_bf16 v[48:63], v[112:115], a[176:179], v[48:63]
    ds_read_b64_tr_b16 v[120:121], v27 offset:5632
    ds_read_b64_tr_b16 v[122:123], v27 offset:6656
    ds_read_b64_tr_b16 v[124:125], v28 offset:5632
    ds_read_b64_tr_b16 v[126:127], v28 offset:6656
    v_mfma_f32_32x32x16_bf16 v[64:79], v[116:119], a[176:179], v[64:79]
    buffer_load_dwordx4 a[208:211], v7, s[36:39], s22 offen offset:2048 sc1
    buffer_load_dwordx4 a[212:215], v7, s[36:39], s23 offen offset:2048 sc1
    v_mfma_f32_32x32x16_bf16 v[80:95], v[112:115], a[180:183], v[80:95]
    v_mfma_f32_32x32x16_bf16 v[96:111], v[116:119], a[180:183], v[96:111]
    s_waitcnt vmcnt(7) lgkmcnt(0)
    v_mfma_f32_32x32x16_bf16 v[48:63], v[120:123], a[184:187], v[48:63]
    ds_read_b64_tr_b16 v[112:113], v27 offset:7168
    ds_read_b64_tr_b16 v[114:115], v27 offset:8192
    ds_read_b64_tr_b16 v[116:117], v28 offset:7168
    ds_read_b64_tr_b16 v[118:119], v28 offset:8192
    v_mfma_f32_32x32x16_bf16 v[64:79], v[124:127], a[184:187], v[64:79]
    buffer_load_dwordx4 a[216:219], v7, s[36:39], s22 offen offset:3072 sc1
    buffer_load_dwordx4 a[220:223], v7, s[36:39], s23 offen offset:3072 sc1
    s_add_u32 s22, s22, 28672
    s_add_u32 s23, s23, 28672
    v_mfma_f32_32x32x16_bf16 v[80:95], v[120:123], a[188:191], v[80:95]
    v_mfma_f32_32x32x16_bf16 v[96:111], v[124:127], a[188:191], v[96:111]
    s_waitcnt vmcnt(6) lgkmcnt(0)
    v_mfma_f32_32x32x16_bf16 v[48:63], v[112:115], a[192:195], v[48:63]
    ds_read_b64_tr_b16 v[120:121], v27 offset:9216
    ds_read_b64_tr_b16 v[122:123], v27 offset:10240
    ds_read_b64_tr_b16 v[124:125], v28 offset:9216
    ds_read_b64_tr_b16 v[126:127], v28 offset:10240
    v_mfma_f32_32x32x16_bf16 v[64:79], v[116:119], a[192:195], v[64:79]
    v_mfma_f32_32x32x16_bf16 v[80:95], v[112:115], a[196:199], v[80:95]
    v_mfma_f32_32x32x16_bf16 v[96:111], v[116:119], a[196:199], v[96:111]
    s_waitcnt vmcnt(4) lgkmcnt(0)
    v_mfma_f32_32x32x16_bf16 v[48:63], v[120:123], a[200:203], v[48:63]
    ds_read_b64_tr_b16 v[112:113], v27 offset:10752
    ds_read_b64_tr_b16 v[114:115], v27 offset:11776
    ds_read_b64_tr_b16 v[116:117], v28 offset:10752
    ds_read_b64_tr_b16 v[118:119], v28 offset:11776
    v_mfma_f32_32x32x16_bf16 v[64:79], v[124:127], a[200:203], v[64:79]
    v_mfma_f32_32x32x16_bf16 v[80:95], v[120:123], a[204:207], v[80:95]
    v_mfma_f32_32x32x16_bf16 v[96:111], v[124:127], a[204:207], v[96:111]
    s_waitcnt vmcnt(2) lgkmcnt(0)
    v_mfma_f32_32x32x16_bf16 v[48:63], v[112:115], a[208:211], v[48:63]
    ds_read_b64_tr_b16 v[120:121], v27 offset:12800
    ds_read_b64_tr_b16 v[122:123], v29 offset:13824
    ds_read_b64_tr_b16 v[124:125], v28 offset:12800
    ds_read_b64_tr_b16 v[126:127], v30 offset:13824
    v_mfma_f32_32x32x16_bf16 v[64:79], v[116:119], a[208:211], v[64:79]
    buffer_load_dwordx2 v[248:249], v18, s[36:39], s18 offen sc1
    v_mfma_f32_32x32x16_bf16 v[80:95], v[112:115], a[212:215], v[80:95]
    v_mfma_f32_32x32x16_bf16 v[96:111], v[116:119], a[212:215], v[96:111]
    s_waitcnt vmcnt(1) lgkmcnt(0)
    v_mfma_f32_32x32x16_bf16 v[48:63], v[120:123], a[216:219], v[48:63]
    ds_read_b64_tr_b16 v[112:113], v27 offset:14336
    ds_read_b64_tr_b16 v[114:115], v27 offset:15360
    ds_read_b64_tr_b16 v[116:117], v28 offset:14336
    ds_read_b64_tr_b16 v[118:119], v28 offset:15360
    v_mfma_f32_32x32x16_bf16 v[64:79], v[124:127], a[216:219], v[64:79]
    v_mfma_f32_32x32x16_bf16 v[80:95], v[120:123], a[220:223], v[80:95]
    v_mfma_f32_32x32x16_bf16 v[96:111], v[124:127], a[220:223], v[96:111]
    s_waitcnt vmcnt(0)
    v_cmp_ne_u64 vcc, s[64:65], v[248:249]
    s_cbranch_vccnz L_po_late
    buffer_load_dwordx4 a[64:67], v7, s[36:39], s22 offen offset:0 sc1
    buffer_load_dwordx4 a[68:71], v7, s[36:39], s23 offen offset:0 sc1
    buffer_load_dwordx4 a[72:75], v7, s[36:39], s22 offen offset:1024 sc1
    buffer_load_dwordx4 a[76:79], v7, s[36:39], s23 offen offset:1024 sc1
    buffer_load_dwordx4 a[80:83], v7, s[36:39], s22 offen offset:2048 sc1
    buffer_load_dwordx4 a[84:87], v7, s[36:39], s23 offen offset:2048 sc1
    buffer_load_dwordx4 a[88:91], v7, s[36:39], s22 offen offset:3072 sc1
    buffer_load_dwordx4 a[92:95], v7, s[36:39], s23 offen offset:3072 sc1
    s_add_u32 s22, s22, 4096
    s_add_u32 s23, s23, 4096
L_po_back:
    s_waitcnt vmcnt(6) lgkmcnt(0)
    v_mfma_f32_32x32x16_bf16 v[48:63], v[112:115], a[64:67], v[48:63]
    ds_read_b64_tr_b16 v[120:121], v27 offset:16384
    ds_read_b64_tr_b16 v[122:123], v27 offset:17408
    ds_read_b64_tr_b16 v[124:125], v28 offset:16384
    ds_read_b64_tr_b16 v[126:127], v28 offset:17408
    v_mfma_f32_32x32x16_bf16 v[64:79], v[116:119], a[64:67], v[64:79]
    buffer_load_dwordx4 a[96:99], v7, s[36:39], s22 offen offset:0 sc1
    buffer_load_dwordx4 a[100:103], v7, s[36:39], s23 offen offset:0 sc1
    v_mfma_f32_32x32x16_bf16 v[80:95], v[112:115], a[68:71], v[80:95]
    v_mfma_f32_32x32x16_bf16 v[96:111], v[116:119], a[68:71], v[96:111]
    s_waitcnt vmcnt(6) lgkmcnt(0)
    v_mfma_f32_32x32x16_bf16 v[48:63], v[120:123], a[72:75], v[48:63]
    ds_read_b64_tr_b16 v[112:113], v27 offset:17920
    ds_read_b64_tr_b16 v[114:115], v27 offset:18944
    ds_read_b64_tr_b16 v[116:117], v28 offset:17920
    ds_read_b64_tr_b16 v[118:119], v28 offset:18944
    v_mfma_f32_32x32x16_bf16 v[64:79], v[124:127], a[72:75], v[64:79]
    buffer_load_dwordx4 a[104:107], v7, s[36:39], s22 offen offset:1024 sc1
    buffer_load_dwordx4 a[108:111], v7, s[36:39], s23 offen offset:1024 sc1
    v_mfma_f32_32x32x16_bf16 v[80:95], v[120:123], a[76:79], v[80:95]
    v_mfma_f32_32x32x16_bf16 v[96:111], v[124:127], a[76:79], v[96:111]
    s_waitcnt vmcnt(6) lgkmcnt(0)
    v_mfma_f32_32x32x16_bf16 v[48:63], v[112:115], a[80:83], v[48:63]
    ds_read_b64_tr_b16 v[120:121], v27 offset:19968
    ds_read_b64_tr_b16 v[122:123], v27 offset:20992
    ds_read_b64_tr_b16 v[124:125], v28 offset:19968
    ds_read_b64_tr_b16 v[126:127], v28 offset:20992
    v_mfma_f32_32x32x16_bf16 v[64:79], v[116:119], a[80:83], v[64:79]
    buffer_load_dwordx4 a[112:115], v7, s[36:39], s22 offen offset:2048 sc1
    buffer_load_dwordx4 a[116:119], v7, s[36:39], s23 offen offset:2048 sc1
    v_mfma_f32_32x32x16_bf16 v[80:95], v[112:115], a[84:87], v[80:95]
    v_mfma_f32_32x32x16_bf16 v[96:111], v[116:119], a[84:87], v[96:111]
    s_waitcnt vmcnt(6) lgkmcnt(0)
    v_mfma_f32_32x32x16_bf16 v[48:63], v[120:123], a[88:91], v[48:63]
    ds_read_b64_tr_b16 v[112:113], v27 offset:21504
    ds_read_b64_tr_b16 v[114:115], v27 offset:22528
    ds_read_b64_tr_b16 v[116:117], v28 offset:21504
    ds_read_b64_tr_b16 v[118:119], v28 offset:22528
    v_mfma_f32_32x32x16_bf16 v[64:79], v[124:127], a[88:91], v[64:79]
    buffer_load_dwordx4 a[120:123], v7, s[36:39], s22 offen offset:3072 sc1
    buffer_load_dwordx4 a[124:127], v7, s[36:39], s23 offen offset:3072 sc1
    v_mfma_f32_32x32x16_bf16 v[80:95], v[120:123], a[92:95], v[80:95]
    v_mfma_f32_32x32x16_bf16 v[96:111], v[124:127], a[92:95], v[96:111]
    s_waitcnt vmcnt(6) lgkmcnt(0)
    v_mfma_f32_32x32x16_bf16 v[48:63], v[112:115], a[96:99], v[48:63]
    ds_read_b64_tr_b16 v[120:121], v27 offset:23552
    ds_read_b64_tr_b16 v[122:123], v27 offset:24576
    ds_read_b64_tr_b16 v[124:125], v28 offset:23552
    ds_read_b64_tr_b16 v[126:127], v28 offset:24576
    v_mfma_f32_32x32x16_bf16 v[64:79], v[116:119], a[96:99], v[64:79]
    v_mfma_f32_32x32x16_bf16 v[80:95], v[112:115], a[100:103], v[80:95]
    v_mfma_f32_32x32x16_bf16 v[96:111], v[116:119], a[100:103], v[96:111]
    s_waitcnt vmcnt(4) lgkmcnt(0)
    v_mfma_f32_32x32x16_bf16 v[48:63], v[120:123], a[104:107], v[48:63]
    ds_read_b64_tr_b16 v[112:113], v27 offset:25088
    ds_read_b64_tr_b16 v[114:115], v27 offset:26112
    ds_read_b64_tr_b16 v[116:117], v28 offset:25088
    ds_read_b64_tr_b16 v[118:119], v28 offset:26112
    v_mfma_f32_32x32x16_bf16 v[64:79], v[124:127], a[104:107], v[64:79]
    v_mfma_f32_32x32x16_bf16 v[80:95], v[120:123], a[108:111], v[80:95]
    v_mfma_f32_32x32x16_bf16 v[96:111], v[124:127], a[108:111], v[96:111]
    s_waitcnt vmcnt(2) lgkmcnt(0)
    v_mfma_f32_32x32x16_bf16 v[48:63], v[112:115], a[112:115], v[48:63]
    ds_read_b64_tr_b16 v[120:121], v27 offset:27136
    ds_read_b64_tr_b16 v[122:123], v29 offset:28160
    ds_read_b64_tr_b16 v[124:125], v28 offset:27136
    ds_read_b64_tr_b16 v[126:127], v30 offset:28160
    v_mfma_f32_32x32x16_bf16 v[64:79], v[116:119], a[112:115], v[64:79]
    v_mfma_f32_32x32x16_bf16 v[80:95], v[112:115], a[116:119], v[80:95]
    v_mfma_f32_32x32x16_bf16 v[96:111], v[116:119], a[116:119], v[96:111]
    s_waitcnt vmcnt(0) lgkmcnt(0)
    v_mfma_f32_32x32x16_bf16 v[48:63], v[120:123], a[120:123], v[48:63]
    v_mfma_f32_32x32x16_bf16 v[64:79], v[124:127], a[120:123], v[64:79]
    v_mfma_f32_32x32x16_bf16 v[80:95], v[120:123], a[124:127], v[80:95]
    v_mfma_f32_32x32x16_bf16 v[96:111], v[124:127], a[124:127], v[96:111]
    s_nop 9
    ds_write_b128 v23, v[64:67] offset:0
    ds_write_b128 v23, v[68:71] offset:1024
    ds_write_b128 v23, v[72:75] offset:2048
    ds_write_b128 v23, v[76:79] offset:3072
    ds_write_b128 v24, v[80:83] offset:0
    ds_write_b128 v24, v[84:87] offset:1024
    ds_write_b128 v24, v[88:91] offset:2048
    ds_write_b128 v24, v[92:95] offset:3072
    ds_write_b128 v25, v[96:99] offset:0
    ds_write_b128 v25, v[100:103] offset:1024
    ds_write_b128 v25, v[104:107] offset:2048
    ds_write_b128 v25, v[108:111] offset:3072
    s_waitcnt lgkmcnt(0)
    s_barrier
    ds_read_b128 v[128:131], v26 offset:0
    ds_read_b128 v[132:135], v26 offset:1024
    ds_read_b128 v[136:139], v26 offset:2048
    ds_read_b128 v[140:143], v26 offset:3072
    ds_read_b128 v[144:147], v26 offset:4096
    ds_read_b128 v[148:151], v26 offset:5120
    ds_read_b128 v[152:155], v26 offset:6144
    ds_read_b128 v[156:159], v26 offset:7168
    ds_read_b128 v[160:163], v26 offset:8192
    ds_read_b128 v[164:167], v26 offset:9216
    ds_read_b128 v[168:171], v26 offset:10240
    ds_read_b128 v[172:175], v26 offset:11264
    s_or_b32 s57, s2, s50
    s_mov_b32 s57, 7897088
    s_cselect_b32 s57, 0x40000000, s57
    s_waitcnt lgkmcnt(8)
    v_pk_add_f32 v[48:49], v[48:49], v[128:129]
    v_pk_add_f32 v[50:51], v[50:51], v[130:131]
    v_pk_add_f32 v[52:53], v[52:53], v[132:133]
    v_pk_add_f32 v[54:55], v[54:55], v[134:135]
    v_pk_add_f32 v[56:57], v[56:57], v[136:137]
    v_pk_add_f32 v[58:59], v[58:59], v[138:139]
    v_pk_add_f32 v[60:61], v[60:61], v[140:141]
    v_pk_add_f32 v[62:63], v[62:63], v[142:143]
    s_waitcnt lgkmcnt(4)
    v_pk_add_f32 v[48:49], v[48:49], v[144:145]
    v_pk_add_f32 v[50:51], v[50:51], v[146:147]
    v_pk_add_f32 v[52:53], v[52:53], v[148:149]
    v_pk_add_f32 v[54:55], v[54:55], v[150:151]
    v_pk_add_f32 v[56:57], v[56:57], v[152:153]
    v_pk_add_f32 v[58:59], v[58:59], v[154:155]
    v_pk_add_f32 v[60:61], v[60:61], v[156:157]
    v_pk_add_f32 v[62:63], v[62:63], v[158:159]
    s_waitcnt lgkmcnt(0)
    v_pk_add_f32 v[48:49], v[48:49], v[160:161]
    v_pk_add_f32 v[50:51], v[50:51], v[162:163]
    v_pk_add_f32 v[52:53], v[52:53], v[164:165]
    v_pk_add_f32 v[54:55], v[54:55], v[166:167]
    v_pk_add_f32 v[56:57], v[56:57], v[168:169]
    v_pk_add_f32 v[58:59], v[58:59], v[170:171]
    v_pk_add_f32 v[60:61], v[60:61], v[172:173]
    v_pk_add_f32 v[62:63], v[62:63], v[174:175]
    v_cvt_pk_bf16_f32 v48, v48, v49
    v_cvt_pk_bf16_f32 v49, v50, v51
    v_cvt_pk_bf16_f32 v50, v52, v53
    v_cvt_pk_bf16_f32 v51, v54, v55
    v_cvt_pk_bf16_f32 v52, v56, v57
    v_cvt_pk_bf16_f32 v53, v58, v59
    v_cvt_pk_bf16_f32 v54, v60, v61
    v_cvt_pk_bf16_f32 v55, v62, v63
    s_nop 1
    v_permlane32_swap_b32 v48, v50
    v_permlane32_swap_b32 v49, v51
    v_permlane32_swap_b32 v52, v54
    v_permlane32_swap_b32 v53, v55
    s_nop 0
    v_permlane16_swap_b32 v48, v52
    v_permlane16_swap_b32 v49, v53
    v_permlane16_swap_b32 v50, v54
    v_permlane16_swap_b32 v51, v55
    s_add_u32 s58, s19, 14336
    buffer_store_dwordx4 v[48:51], v31, s[40:43], s19 offen sc1
    buffer_store_dwordx4 v[52:55], v31, s[40:43], s58 offen offset:0 sc1
    s_mov_b64 exec, 0xff
    buffer_store_dwordx4 v[252:255], v7, s[36:39], s57 offen sc1
L_end:
    s_endpgm
L_np:
    s_mov_b32 s13, 7897088
    s_load_dword s12, s[24:25], s13
    s_sub_u32 s57, s3, 42
    s_lshl_b32 s57, s57, 2
    s_add_u32 s57, s57, s44
    s_lshl_b32 s57, s57, 2
    s_add_u32 s57, s57, s50
    v_lshlrev_b32 v6, 7, v1
    s_mov_b32 s40, s4
    s_mov_b32 s41, s5
    s_mov_b32 s42, 0x1c0000
    s_mul_i32 s58, s57, 5248
    s_lshr_b64 exec, -1, 23
    buffer_load_dword v250, v6, s[40:43], s58 offen
    s_mov_b32 s40, s10
    s_mov_b32 s41, s11
    s_mov_b32 s42, 0x62000
    s_mul_i32 s58, s57, 1152
    s_mov_b64 exec, 0x1ff
    buffer_load_dword v250, v6, s[40:43], s58 offen
    s_mov_b32 s40, s16
    s_mov_b32 s41, s17
    buffer_load_dword v250, v6, s[40:43], s58 offen
    s_mov_b64 exec, -1
    s_branch L_np1
L_gate:
    s_waitcnt lgkmcnt(0)
    v_bfi_b32 v112, v93, v176, v112
    v_bfi_b32 v113, v93, v177, v113
    v_bfi_b32 v114, v93, v178, v114
    v_bfi_b32 v115, v93, v179, v115
    v_bfi_b32 v116, v93, v176, v116
    v_bfi_b32 v117, v93, v177, v117
    v_bfi_b32 v118, v93, v178, v118
    v_bfi_b32 v119, v93, v179, v119
    v_bfi_b32 v120, v93, v176, v120
    v_bfi_b32 v121, v93, v177, v121
    v_bfi_b32 v122, v93, v178, v122
    v_bfi_b32 v123, v93, v179, v123
    v_bfi_b32 v124, v93, v176, v124
    v_bfi_b32 v125, v93, v177, v125
    v_bfi_b32 v126, v93, v178, v126
    v_bfi_b32 v127, v93, v179, v127
    s_branch L_gate_r
L_pw_s:
    s_mov_b32 s3, 0
L_pw_r:
    s_mov_b64 exec, vcc
    buffer_load_dwordx2 v[248:249], v247, s[36:39], s55 offen sc1
    s_mov_b64 exec, -1
    s_add_u32 s3, s3, 1
    s_waitcnt vmcnt(0)
    v_cmp_ne_u64 vcc, s[64:65], v[248:249]
    s_cmp_gt_u32 s3, 262144
    s_cbranch_scc1 L_pw_ok
    s_cbranch_vccnz L_pw_r
    s_branch L_pw_ok
L_pb_s:
    s_mov_b32 s3, 0
L_pb_r:
    s_mov_b64 exec, vcc
    buffer_load_dwordx2 v[248:249], v16, s[36:39], s47 offen sc1
    s_mov_b64 exec, -1
    s_add_u32 s3, s3, 1
    s_waitcnt vmcnt(0)
    v_cmp_ne_u64 vcc, s[64:65], v[248:249]
    s_cmp_gt_u32 s3, 262144
    s_cbranch_scc1 L_pb_ok
    s_cbranch_vccnz L_pb_r
    s_branch L_pb_ok
L_pk_s:
    s_mov_b32 s3, 0
L_pk_r:
    s_mov_b64 exec, vcc
    buffer_load_dwordx2 v[248:249], v17, s[36:39], s55 offen sc1
    s_mov_b64 exec, -1
    s_add_u32 s3, s3, 1
    s_waitcnt vmcnt(0)
    v_cmp_ne_u64 vcc, s[64:65], v[248:249]
    s_cmp_gt_u32 s3, 262144
    s_cbranch_scc1 L_pk_ok
    s_cbranch_vccnz L_pk_r
    s_branch L_pk_ok
L_nop3:
    s_waitcnt vmcnt(0)
    s_barrier
    s_mov_b64 exec, 0xff
    buffer_store_dwordx4 v[252:255], v7, s[36:39], s7 offen sc1
    s_mov_b64 exec, -1
    s_endpgm
L_pa_s:
    s_mov_b32 s3, 0
L_pa_r:
    s_mov_b64 exec, vcc
    buffer_load_dwordx2 v[248:249], v18, s[36:39], s18 offen sc1
    s_mov_b64 exec, -1
    s_add_u32 s3, s3, 1
    s_waitcnt vmcnt(0)
    v_cmp_ne_u64 vcc, s[64:65], v[248:249]
    s_cmp_gt_u32 s3, 262144
    s_cbranch_scc1 L_pa_ok
    s_cbranch_vccnz L_pa_r
    s_branch L_pa_ok
L_po_s:
    s_mov_b32 s3, 0
L_po_r:
    s_mov_b64 exec, vcc
    buffer_load_dwordx2 v[248:249], v18, s[36:39], s18 offen sc1
    s_mov_b64 exec, -1
    s_add_u32 s3, s3, 1
    s_waitcnt vmcnt(0)
    v_cmp_ne_u64 vcc, s[64:65], v[248:249]
    s_cmp_gt_u32 s3, 262144
    s_cbranch_scc1 L_po_ok
    s_cbranch_vccnz L_po_r
    s_branch L_po_ok
L_po_late:
    buffer_load_dwordx2 v[248:249], v18, s[36:39], s18 offen sc1
    s_waitcnt vmcnt(0)
    v_cmp_ne_u64 vcc, s[64:65], v[248:249]
    s_cbranch_vccnz L_po_s
L_po_ok:
    buffer_load_dwordx4 a[64:67], v7, s[36:39], s22 offen offset:0 sc1
    buffer_load_dwordx4 a[68:71], v7, s[36:39], s23 offen offset:0 sc1
    buffer_load_dwordx4 a[72:75], v7, s[36:39], s22 offen offset:1024 sc1
    buffer_load_dwordx4 a[76:79], v7, s[36:39], s23 offen offset:1024 sc1
    buffer_load_dwordx4 a[80:83], v7, s[36:39], s22 offen offset:2048 sc1
    buffer_load_dwordx4 a[84:87], v7, s[36:39], s23 offen offset:2048 sc1
    buffer_load_dwordx4 a[88:91], v7, s[36:39], s22 offen offset:3072 sc1
    buffer_load_dwordx4 a[92:95], v7, s[36:39], s23 offen offset:3072 sc1
    s_add_u32 s22, s22, 4096
    s_add_u32 s23, s23, 4096
    s_branch L_po_back
L2_fallback:
    s_mul_i32 s59, s48, 278528
    s_add_u32 s59, s59, 2752512
    s_mov_b32 s57, s59
    s_mov_b32 s3, 0
    v_and_b32 v182, v182, v10
    v_and_b32 v183, v183, v10
    v_mov_b32 v208, 0xff800000
L2_f1:
    buffer_load_dwordx4 v[192:195], v7, s[36:39], s57 offen sc1
    buffer_load_dwordx4 v[196:199], v7, s[36:39], s57 offen offset:1024 sc1
    s_waitcnt vmcnt(0)
    v_mfma_f32_32x32x16_bf16 v[48:63], v[192:195], v[176:179], 0
    v_mfma_f32_32x32x16_bf16 v[48:63], v[196:199], v[180:183], v[48:63]
    s_nop 12
    v_max3_f32 v3, v48, v49, v50
    v_max3_f32 v3, v3, v51, v52
    v_max3_f32 v3, v3, v53, v54
    v_max3_f32 v3, v3, v55, v56
    v_max3_f32 v3, v3, v57, v58
    v_max3_f32 v3, v3, v59, v60
    v_max3_f32 v3, v3, v61, v62
    v_max_f32 v3, v3, v63
    v_max_f32 v208, v208, v3
    s_add_u32 s57, s57, 4352
    s_add_u32 s3, s3, 1
    s_cmp_lt_u32 s3, 64
    s_cbranch_scc1 L2_f1
    v_mov_b32 v3, v208
    s_nop 1
    v_permlane32_swap_b32 v3, v208
    v_max_f32 v3, v3, v208
    s_mov_b64 exec, s[62:63]
    v_xor_b32 v3, 0x80000000, v3
    v_and_b32 v4, 0xffff0000, v3
    v_sub_f32 v3, v3, v4
    v_and_b32 v5, 0xffff0000, v3
    v_sub_f32 v3, v3, v5
    v_lshrrev_b32 v4, 16, v4
    v_or_b32 v182, v4, v5
    v_lshrrev_b32 v183, 16, v3
    s_mov_b64 exec, -1
    s_mov_b32 s57, s59
    s_mov_b32 s3, 0
    v_mov_b32 v32, 0
    v_mov_b32 v33, 0
    v_mov_b32 v34, 0
    v_mov_b32 v35, 0
    v_mov_b32 v36, 0
    v_mov_b32 v37, 0
    v_mov_b32 v38, 0
    v_mov_b32 v39, 0
    v_mov_b32 v40, 0
    v_mov_b32 v41, 0
    v_mov_b32 v42, 0
    v_mov_b32 v43, 0
    v_mov_b32 v44, 0
    v_mov_b32 v45, 0
    v_mov_b32 v46, 0
    v_mov_b32 v47, 0
L2_f2:
    buffer_load_dwordx4 v[192:195], v7, s[36:39], s57 offen offset:0 sc1
    buffer_load_dwordx4 v[196:199], v7, s[36:39], s57 offen offset:1024 sc1
    buffer_load_dwordx4 v[200:203], v7, s[36:39], s57 offen offset:2048 sc1
    buffer_load_dwordx4 v[204:207], v7, s[36:39], s57 offen offset:3072 sc1
    s_waitcnt vmcnt(0)
    v_mfma_f32_32x32x16_bf16 v[48:63], v[192:195], v[176:179], 0
    v_mfma_f32_32x32x16_bf16 v[48:63], v[196:199], v[180:183], v[48:63]
    s_nop 12
    v_exp_f32 v48, v48
    v_exp_f32 v49, v49
    v_exp_f32 v50, v50
    v_exp_f32 v51, v51
    v_exp_f32 v52, v52
    v_exp_f32 v53, v53
    v_exp_f32 v54, v54
    v_exp_f32 v55, v55
    v_exp_f32 v56, v56
    v_exp_f32 v57, v57
    v_exp_f32 v58, v58
    v_exp_f32 v59, v59
    v_exp_f32 v60, v60
    v_exp_f32 v61, v61
    v_exp_f32 v62, v62
    v_exp_f32 v63, v63
    s_nop 1
    v_smfmac_f32_32x32x32_bf16 v[32:47], v[200:203], v[48:55], v8
    v_smfmac_f32_32x32x32_bf16 v[32:47], v[204:207], v[56:63], v8
    s_add_u32 s57, s57, 4352
    s_add_u32 s3, s3, 1
    s_cmp_lt_u32 s3, 64
    s_nop 12
    s_cbranch_scc1 L2_f2
    v_mov_b32 v3, v44
    v_mov_b32 v4, v44
    v_sub_f32 v5, 1.0, v11
    s_nop 0
    v_permlane32_swap_b32 v3, v4
    v_rcp_f32 v4, v4
    s_nop 0
    v_mul_f32 v168, v4, v5
    s_branch L2_fin
L_code_end:
.section .rodata,"a"
.p2align 6
.amdhsa_kernel gated_mix__linear_kernel_hedgehog__softmax_full_mha__prompt_kernel
  .amdhsa_next_free_vgpr 512
  .amdhsa_next_free_sgpr 102
  .amdhsa_accum_offset 256
  .amdhsa_group_segment_fixed_size 0
  .amdhsa_kernarg_size 88
  .amdhsa_user_sgpr_count 2
  .amdhsa_user_sgpr_kernarg_segment_ptr 1
  .amdhsa_system_sgpr_workgroup_id_x 1
.end_amdhsa_kernel
```
